```python
import torch

def _softmax(x, axis=-1):
    return torch.softmax(x, dim=axis)
def _gelu(x):
    return torch.nn.functional.gelu(x, approximate="tanh")
def _silu(x):
    return torch.nn.functional.silu(x)
def _sigmoid(x):
    return torch.sigmoid(x)
def _layernorm(x, axis=-1, eps=1e-5):
    m = x.mean(dim=axis, keepdim=True)
    v = x.var(dim=axis, keepdim=True, unbiased=False)
    return (x - m) / torch.sqrt(v + eps)
def _scatter_add(tgt, idx, src, axis=0):
    return tgt.clone().index_add_(axis, idx, src)
def _segment_sum(src, seg, n):
    out = torch.zeros((n,) + src.shape[1:], dtype=src.dtype)
    return out.index_add_(0, seg, src)
def _pad(x, pw):
    flat = tuple(v for pair in reversed(pw) for v in pair)
    return torch.nn.functional.pad(x, flat)

kernel_name = 'sequential_preLN__gqa_block_cached__geglu_ffn__decode'

def setup_inputs():

    _w = (lambda a: (lambda t: t.to(torch.bfloat16) if t.is_floating_point() else t)(torch.as_tensor(a)))
    def _A_setup():
        B, Sq, D = 4, 1, 512
        Hq, Hkv, Sk, Dh = 32, 8, 16384, 128
        assert Hq % Hkv == 0, (Hq, Hkv)
        return {
            "x": _w((lambda *s: torch.randn(*s, dtype=torch.bfloat16) * 0.05)(B, Sq, D)),
            "k_cache": _w((lambda *s: torch.randn(*s, dtype=torch.bfloat16) * 3.2)(B, Hkv, Sk, Dh)),
            "v_cache": _w((lambda *s: torch.randn(*s, dtype=torch.bfloat16) * 0.4)(B, Hkv, Sk, Dh)),
            "wq": _w((lambda *s: torch.randn(*s, dtype=torch.bfloat16) * 3.2)(D, Hq * Dh) * (D ** -0.5)),
            "wo": _w((lambda *s: torch.randn(*s, dtype=torch.bfloat16) * 0.4)(Hq * Dh, D) * ((Hq * Dh) ** -0.5)),
        }
    _A_in = _A_setup()

    def _B_setup():
        B, S, D, F = 4, 1, 512, 1792
        return {
            "x": _w((lambda *s: torch.randn(*s, dtype=torch.bfloat16) * 0.05)(B, S, D)),
            "w_gate": _w((lambda *s: torch.randn(*s, dtype=torch.bfloat16) * 0.05)(D, F)),
            "w_up": _w((lambda *s: torch.randn(*s, dtype=torch.bfloat16) * 0.05)(D, F)),
            "w_down": _w((lambda *s: torch.randn(*s, dtype=torch.bfloat16) * 0.05)(F, D)),
        }
    _B_in = _B_setup()

    return {
        "A_x": _A_in["x"],
        "A_k_cache": _A_in["k_cache"],
        "A_v_cache": _A_in["v_cache"],
        "A_wq": _A_in["wq"],
        "A_wo": _A_in["wo"],
        "B_x": _B_in["x"],
        "B_w_gate": _B_in["w_gate"],
        "B_w_up": _B_in["w_up"],
        "B_w_down": _B_in["w_down"],
    }

def reference(A_x, A_k_cache, A_v_cache, A_wq, A_wo, B_x, B_w_gate, B_w_up, B_w_down):
    def _A_ref(x, k_cache, v_cache, wq, wo):
        B, Sq, D = x.shape
        Hq, Dh = 32, 128
        Hkv = k_cache.shape[1]
        rep = Hq // Hkv
        q = (lambda x, *d: x.permute(*d))((x @ wq).reshape(B, Sq, Hq, Dh), 0, 2, 1, 3)
        k = (lambda x, n, axis: torch.repeat_interleave(x, n, dim=axis))(k_cache, rep, axis=1)
        v = (lambda x, n, axis: torch.repeat_interleave(x, n, dim=axis))(v_cache, rep, axis=1)
        scores = torch.einsum("bhqd,bhkd->bhqk", q, k) * (Dh ** -0.5)
        p = _softmax(scores, axis=-1)
        o = torch.einsum("bhqk,bhkd->bhqd", p, v)
        return (lambda x, *d: x.permute(*d))(o, 0, 2, 1, 3).reshape(B, Sq, Hq * Dh) @ wo

    def _B_ref(x, w_gate, w_up, w_down):
        return (_gelu(x @ w_gate) * (x @ w_up)) @ w_down

    x = A_x
    h = x + _A_ref(_layernorm(x, axis=-1), A_k_cache, A_v_cache, A_wq, A_wo)
    h2 = h + _B_ref(_layernorm(h, axis=-1), B_w_gate, B_w_up, B_w_down)
    return h2
```

```asm
; @launch grid=(256,1,1) block=(512,1,1) lds=141824
.amdgcn_target "amdgcn-amd-amdhsa--gfx950"
.text
.globl sequential_preLN__gqa_block_cached__geglu_ffn__decode_kernel
.p2align 8
.type sequential_preLN__gqa_block_cached__geglu_ffn__decode_kernel,@function
sequential_preLN__gqa_block_cached__geglu_ffn__decode_kernel:
    s_cmp_ge_u32 s2, 256
    s_cbranch_scc1 L_end
    s_load_dwordx16 s[16:31], s[0:1], 0
    s_load_dwordx8 s[32:39], s[0:1], 64
    v_lshrrev_b32 v1, 6, v0
    v_and_b32 v0, 63, v0
    s_nop 0
    v_readfirstlane_b32 s68, v1
    s_and_b32 s74, s2, 7
    s_lshr_b32 s76, s2, 3
    s_mul_i32 s78, s74, 4
    s_add_u32 s76, s76, s78
    s_and_b32 s76, s76, 31
    s_and_b32 s73, s76, 7
    s_lshr_b32 s75, s76, 3
    s_cmp_gt_u32 s73, s74
    s_subb_u32 s78, s73, 0
    s_mul_i32 s77, s74, 6
    s_add_u32 s77, s77, s78
    s_add_u32 s79, s74, 48
    s_cmp_ge_u32 s78, 6
    s_cselect_b32 s77, s79, s77
    s_cmp_gt_u32 s74, s73
    s_subb_u32 s78, s74, 0
    s_add_u32 s78, s78, s73
    s_xor_b32 s78, s78, s75
    s_and_b32 s78, s78, 1
    s_cmp_eq_u32 s74, s73
    s_cselect_b32 s77, 63, s77
    s_cmp_lg_u32 s78, 0
    s_cselect_b32 s77, 62, s77
    s_mov_b32 s71, 0x3db504f3
    s_mov_b32 s72, 0x3fb8aa3b
    v_and_b32 v1, 15, v0
    v_lshrrev_b32 v2, 4, v0
    s_cmp_ge_u32 s68, 4
    s_cbranch_scc1 L_helper
    s_lshl_b32 s78, s76, 22
    s_lshl_b32 s79, s74, 2
    s_add_u32 s79, s79, s68
    s_mul_i32 s83, s76, 65536
    s_lshl_b32 s80, s79, 12
    s_add_u32 s80, s80, s83
    s_mul_i32 s70, s68, 16384
    s_add_u32 s70, s70, 10752
    s_lshl_b32 s82, s76, 8
    s_add_u32 s82, s82, 32768
    v_add_u32 v26, 0, v2
    v_xor_b32 v26, v26, v1
    v_lshlrev_b32 v26, 4, v26
    v_lshl_or_b32 v4, v2, 8, v26
    v_add_u32 v26, 4, v2
    v_xor_b32 v26, v26, v1
    v_lshlrev_b32 v26, 4, v26
    v_lshl_or_b32 v5, v2, 8, v26
    v_add_u32 v26, 8, v2
    v_xor_b32 v26, v26, v1
    v_lshlrev_b32 v26, 4, v26
    v_lshl_or_b32 v6, v2, 8, v26
    v_add_u32 v26, 12, v2
    v_xor_b32 v26, v26, v1
    v_lshlrev_b32 v26, 4, v26
    v_lshl_or_b32 v7, v2, 8, v26
    s_waitcnt lgkmcnt(0)
    s_mov_b32 s40, s18
    s_and_b32 s41, s19, 0xffff
    s_mov_b32 s42, 0x8000000
    s_mov_b32 s43, 0x00020000
    s_mov_b32 s44, s20
    s_and_b32 s45, s21, 0xffff
    s_mov_b32 s46, 0x8000000
    s_mov_b32 s47, 0x00020000
    s_mov_b32 s48, s38
    s_and_b32 s49, s39, 0xffff
    s_mov_b32 s50, 0x20000000
    s_mov_b32 s51, 0x00020000
    s_barrier
    s_add_u32 s69, s80, 0
    s_and_b32 s69, s69, 0x3fffff
    s_or_b32 s69, s69, s78
    s_add_u32 m0, s70, 0
    s_nop 0
    buffer_load_dwordx4 v4, s[40:43], s69 offen offset:0 nt lds
    buffer_load_dwordx4 v5, s[40:43], s69 offen offset:1024 nt lds
    buffer_load_dwordx4 v6, s[40:43], s69 offen offset:2048 nt lds
    buffer_load_dwordx4 v7, s[40:43], s69 offen offset:3072 nt lds
    v_add_u32 v26, 0, v2
    v_lshlrev_b32 v26, 1, v26
    v_xor_b32 v26, v26, v1
    v_lshlrev_b32 v26, 4, v26
    v_lshl_or_b32 v8, v2, 8, v26
    v_add_u32 v26, 4, v2
    v_lshlrev_b32 v26, 1, v26
    v_xor_b32 v26, v26, v1
    v_lshlrev_b32 v26, 4, v26
    v_lshl_or_b32 v9, v2, 8, v26
    v_add_u32 v26, 0, v2
    v_xor_b32 v26, v26, v1
    v_lshlrev_b32 v26, 4, v26
    v_lshl_or_b32 v26, v1, 8, v26
    v_add_u32 v10, s70, v26
    v_add_u32 v26, 4, v2
    v_xor_b32 v26, v26, v1
    v_lshlrev_b32 v26, 4, v26
    v_lshl_or_b32 v26, v1, 8, v26
    v_add_u32 v11, s70, v26
    v_add_u32 v26, 8, v2
    v_xor_b32 v26, v26, v1
    v_lshlrev_b32 v26, 4, v26
    v_lshl_or_b32 v26, v1, 8, v26
    v_add_u32 v12, s70, v26
    v_add_u32 v26, 12, v2
    v_xor_b32 v26, v26, v1
    v_lshlrev_b32 v26, 4, v26
    v_lshl_or_b32 v26, v1, 8, v26
    v_add_u32 v13, s70, v26
    v_lshrrev_b32 v26, 2, v1
    v_lshl_add_u32 v26, v2, 2, v26
    v_and_b32 v27, 7, v26
    v_lshlrev_b32 v27, 5, v27
    v_lshl_or_b32 v27, v26, 8, v27
    v_and_b32 v28, 3, v1
    v_lshl_or_b32 v27, v28, 3, v27
    v_xor_b32 v26, 0, v27
    v_add_u32 v14, s70, v26
    v_xor_b32 v26, 32, v27
    v_add_u32 v15, s70, v26
    v_xor_b32 v26, 64, v27
    v_add_u32 v16, s70, v26
    v_xor_b32 v26, 96, v27
    v_add_u32 v17, s70, v26
    v_xor_b32 v26, 128, v27
    v_add_u32 v18, s70, v26
    v_xor_b32 v26, 160, v27
    v_add_u32 v19, s70, v26
    v_xor_b32 v26, 192, v27
    v_add_u32 v20, s70, v26
    v_xor_b32 v26, 224, v27
    v_add_u32 v21, s70, v26
    v_mov_b32 v22, 0xff800000
    v_mov_b32 v23, 0
    v_mov_b32 v253, 0
    s_add_u32 s81, s79, 4294967264
    v_mov_b32 v25, s81
    s_waitcnt vmcnt(0)
    ds_read_b128 v[60:63], v10 offset:0
    ds_read_b128 v[64:67], v11 offset:0
    ds_read_b128 v[68:71], v12 offset:0
    ds_read_b128 v[72:75], v13 offset:0
    s_waitcnt lgkmcnt(0)
    s_add_u32 s69, s80, 2097152
    s_and_b32 s69, s69, 0x3fffff
    s_or_b32 s69, s69, s78
    s_add_u32 m0, s70, 4096
    s_nop 0
    buffer_load_dwordx4 v4, s[40:43], s69 offen offset:0 nt lds
    buffer_load_dwordx4 v5, s[40:43], s69 offen offset:1024 nt lds
    buffer_load_dwordx4 v6, s[40:43], s69 offen offset:2048 nt lds
    buffer_load_dwordx4 v7, s[40:43], s69 offen offset:3072 nt lds
    s_waitcnt vmcnt(0)
    ds_read_b128 v[76:79], v10 offset:4096
    ds_read_b128 v[80:83], v11 offset:4096
    ds_read_b128 v[84:87], v12 offset:4096
    ds_read_b128 v[88:91], v13 offset:4096
    s_waitcnt lgkmcnt(0)
    s_add_u32 s69, s80, 131072
    s_and_b32 s69, s69, 0x3fffff
    s_or_b32 s69, s69, s78
    s_add_u32 m0, s70, 8192
    s_nop 0
    buffer_load_dwordx4 v4, s[40:43], s69 offen offset:0 nt lds
    buffer_load_dwordx4 v5, s[40:43], s69 offen offset:1024 nt lds
    buffer_load_dwordx4 v6, s[40:43], s69 offen offset:2048 nt lds
    buffer_load_dwordx4 v7, s[40:43], s69 offen offset:3072 nt lds
    s_waitcnt vmcnt(0)
    ds_read_b128 v[92:95], v10 offset:8192
    ds_read_b128 v[96:99], v11 offset:8192
    ds_read_b128 v[100:103], v12 offset:8192
    ds_read_b128 v[104:107], v13 offset:8192
    s_waitcnt lgkmcnt(0)
    s_add_u32 s69, s80, 2228224
    s_and_b32 s69, s69, 0x3fffff
    s_or_b32 s69, s69, s78
    s_add_u32 m0, s70, 12288
    s_nop 0
    buffer_load_dwordx4 v4, s[40:43], s69 offen offset:0 nt lds
    buffer_load_dwordx4 v5, s[40:43], s69 offen offset:1024 nt lds
    buffer_load_dwordx4 v6, s[40:43], s69 offen offset:2048 nt lds
    buffer_load_dwordx4 v7, s[40:43], s69 offen offset:3072 nt lds
    s_add_u32 s69, s80, 262144
    s_and_b32 s69, s69, 0x3fffff
    s_or_b32 s69, s69, s78
    s_add_u32 m0, s70, 0
    s_nop 0
    buffer_load_dwordx4 v4, s[40:43], s69 offen offset:0 nt lds
    buffer_load_dwordx4 v5, s[40:43], s69 offen offset:1024 nt lds
    buffer_load_dwordx4 v6, s[40:43], s69 offen offset:2048 nt lds
    buffer_load_dwordx4 v7, s[40:43], s69 offen offset:3072 nt lds
    s_add_u32 s69, s80, 2359296
    s_and_b32 s69, s69, 0x3fffff
    s_or_b32 s69, s69, s78
    s_add_u32 m0, s70, 4096
    s_nop 0
    buffer_load_dwordx4 v4, s[40:43], s69 offen offset:0 nt lds
    buffer_load_dwordx4 v5, s[40:43], s69 offen offset:1024 nt lds
    buffer_load_dwordx4 v6, s[40:43], s69 offen offset:2048 nt lds
    buffer_load_dwordx4 v7, s[40:43], s69 offen offset:3072 nt lds
    s_add_u32 s69, s80, 393216
    s_and_b32 s69, s69, 0x3fffff
    s_or_b32 s69, s69, s78
    s_add_u32 m0, s70, 8192
    s_nop 0
    buffer_load_dwordx4 v4, s[40:43], s69 offen offset:0 nt lds
    buffer_load_dwordx4 v5, s[40:43], s69 offen offset:1024 nt lds
    buffer_load_dwordx4 v6, s[40:43], s69 offen offset:2048 nt lds
    buffer_load_dwordx4 v7, s[40:43], s69 offen offset:3072 nt lds
    s_waitcnt vmcnt(12)
    ds_read_b128 v[108:111], v10 offset:12288
    ds_read_b128 v[112:115], v11 offset:12288
    ds_read_b128 v[116:119], v12 offset:12288
    ds_read_b128 v[120:123], v13 offset:12288
    s_waitcnt lgkmcnt(0)
    s_add_u32 s69, s80, 2490368
    s_and_b32 s69, s69, 0x3fffff
    s_or_b32 s69, s69, s78
    s_add_u32 m0, s70, 12288
    s_nop 0
    buffer_load_dwordx4 v4, s[40:43], s69 offen offset:0 nt lds
    buffer_load_dwordx4 v5, s[40:43], s69 offen offset:1024 nt lds
    buffer_load_dwordx4 v6, s[40:43], s69 offen offset:2048 nt lds
    buffer_load_dwordx4 v7, s[40:43], s69 offen offset:3072 nt lds
    s_waitcnt vmcnt(12)
    ds_read_b128 v[124:127], v10 offset:0
    ds_read_b128 v[128:131], v11 offset:0
    ds_read_b128 v[132:135], v12 offset:0
    ds_read_b128 v[136:139], v13 offset:0
    s_waitcnt lgkmcnt(0)
    s_add_u32 s69, s80, 524288
    s_and_b32 s69, s69, 0x3fffff
    s_or_b32 s69, s69, s78
    s_add_u32 m0, s70, 0
    s_nop 0
    buffer_load_dwordx4 v4, s[40:43], s69 offen offset:0 nt lds
    buffer_load_dwordx4 v5, s[40:43], s69 offen offset:1024 nt lds
    buffer_load_dwordx4 v6, s[40:43], s69 offen offset:2048 nt lds
    buffer_load_dwordx4 v7, s[40:43], s69 offen offset:3072 nt lds
    s_waitcnt vmcnt(12)
    ds_read_b128 v[140:143], v10 offset:4096
    ds_read_b128 v[144:147], v11 offset:4096
    ds_read_b128 v[148:151], v12 offset:4096
    ds_read_b128 v[152:155], v13 offset:4096
    s_waitcnt lgkmcnt(0)
    s_add_u32 s69, s80, 2621440
    s_and_b32 s69, s69, 0x3fffff
    s_or_b32 s69, s69, s78
    s_add_u32 m0, s70, 4096
    s_nop 0
    buffer_load_dwordx4 v4, s[40:43], s69 offen offset:0 nt lds
    buffer_load_dwordx4 v5, s[40:43], s69 offen offset:1024 nt lds
    buffer_load_dwordx4 v6, s[40:43], s69 offen offset:2048 nt lds
    buffer_load_dwordx4 v7, s[40:43], s69 offen offset:3072 nt lds
    s_waitcnt vmcnt(12)
    ds_read_b128 v[156:159], v10 offset:8192
    ds_read_b128 v[160:163], v11 offset:8192
    ds_read_b128 v[164:167], v12 offset:8192
    ds_read_b128 v[168:171], v13 offset:8192
    s_waitcnt lgkmcnt(0)
    s_add_u32 s69, s80, 655360
    s_and_b32 s69, s69, 0x3fffff
    s_or_b32 s69, s69, s78
    s_add_u32 m0, s70, 8192
    s_nop 0
    buffer_load_dwordx4 v4, s[40:43], s69 offen offset:0 nt lds
    buffer_load_dwordx4 v5, s[40:43], s69 offen offset:1024 nt lds
    buffer_load_dwordx4 v6, s[40:43], s69 offen offset:2048 nt lds
    buffer_load_dwordx4 v7, s[40:43], s69 offen offset:3072 nt lds
    s_waitcnt vmcnt(12)
    ds_read_b128 v[172:175], v10 offset:12288
    ds_read_b128 v[176:179], v11 offset:12288
    ds_read_b128 v[180:183], v12 offset:12288
    ds_read_b128 v[184:187], v13 offset:12288
    s_waitcnt lgkmcnt(0)
    s_add_u32 s69, s80, 2752512
    s_and_b32 s69, s69, 0x3fffff
    s_or_b32 s69, s69, s78
    s_add_u32 m0, s70, 12288
    s_nop 0
    buffer_load_dwordx4 v4, s[40:43], s69 offen offset:0 nt lds
    buffer_load_dwordx4 v5, s[40:43], s69 offen offset:1024 nt lds
    buffer_load_dwordx4 v6, s[40:43], s69 offen offset:2048 nt lds
    buffer_load_dwordx4 v7, s[40:43], s69 offen offset:3072 nt lds
    s_waitcnt vmcnt(12)
    ds_read_b128 v[188:191], v10 offset:0
    ds_read_b128 v[192:195], v11 offset:0
    ds_read_b128 v[196:199], v12 offset:0
    ds_read_b128 v[200:203], v13 offset:0
    s_waitcnt lgkmcnt(0)
    s_add_u32 s69, s80, 0
    s_and_b32 s69, s69, 0x3fffff
    s_or_b32 s69, s69, s78
    s_add_u32 m0, s70, 0
    s_nop 0
    buffer_load_dwordx4 v8, s[44:47], s69 offen offset:0 nt lds
    buffer_load_dwordx4 v9, s[44:47], s69 offen offset:1024 nt lds
    buffer_load_dwordx4 v8, s[44:47], s69 offen offset:2048 nt lds
    buffer_load_dwordx4 v9, s[44:47], s69 offen offset:3072 nt lds
    s_waitcnt vmcnt(12)
    ds_read_b128 v[204:207], v10 offset:4096
    ds_read_b128 v[208:211], v11 offset:4096
    ds_read_b128 v[212:215], v12 offset:4096
    ds_read_b128 v[216:219], v13 offset:4096
    s_waitcnt lgkmcnt(0)
    s_add_u32 s69, s80, 2097152
    s_and_b32 s69, s69, 0x3fffff
    s_or_b32 s69, s69, s78
    s_add_u32 m0, s70, 4096
    s_nop 0
    buffer_load_dwordx4 v8, s[44:47], s69 offen offset:0 nt lds
    buffer_load_dwordx4 v9, s[44:47], s69 offen offset:1024 nt lds
    buffer_load_dwordx4 v8, s[44:47], s69 offen offset:2048 nt lds
    buffer_load_dwordx4 v9, s[44:47], s69 offen offset:3072 nt lds
    s_waitcnt vmcnt(12)
    ds_read_b128 v[220:223], v10 offset:8192
    ds_read_b128 v[224:227], v11 offset:8192
    ds_read_b128 v[228:231], v12 offset:8192
    ds_read_b128 v[232:235], v13 offset:8192
    s_waitcnt lgkmcnt(0)
    s_add_u32 s69, s80, 131072
    s_and_b32 s69, s69, 0x3fffff
    s_or_b32 s69, s69, s78
    s_add_u32 m0, s70, 8192
    s_nop 0
    buffer_load_dwordx4 v8, s[44:47], s69 offen offset:0 nt lds
    buffer_load_dwordx4 v9, s[44:47], s69 offen offset:1024 nt lds
    buffer_load_dwordx4 v8, s[44:47], s69 offen offset:2048 nt lds
    buffer_load_dwordx4 v9, s[44:47], s69 offen offset:3072 nt lds
    s_waitcnt vmcnt(12)
    ds_read_b128 v[236:239], v10 offset:12288
    ds_read_b128 v[240:243], v11 offset:12288
    ds_read_b128 v[244:247], v12 offset:12288
    ds_read_b128 v[248:251], v13 offset:12288
    s_waitcnt lgkmcnt(0)
    s_add_u32 s69, s80, 2228224
    s_and_b32 s69, s69, 0x3fffff
    s_or_b32 s69, s69, s78
    s_add_u32 m0, s70, 12288
    s_nop 0
    buffer_load_dwordx4 v8, s[44:47], s69 offen offset:0 nt lds
    buffer_load_dwordx4 v9, s[44:47], s69 offen offset:1024 nt lds
    buffer_load_dwordx4 v8, s[44:47], s69 offen offset:2048 nt lds
    buffer_load_dwordx4 v9, s[44:47], s69 offen offset:3072 nt lds
    v_and_b32 v26, 3, v1
    v_lshlrev_b32 v26, 8, v26
    v_lshl_or_b32 v26, v2, 4, v26
    s_barrier
    ds_read_b128 v[36:39], v26 offset:4096
    ds_read_b128 v[40:43], v26 offset:4160
    ds_read_b128 v[44:47], v26 offset:4224
    ds_read_b128 v[48:51], v26 offset:4288
    s_waitcnt lgkmcnt(0)
    v_mfma_f32_16x16x32_bf16 v[52:55], v[60:63], v[36:39], 0
    v_mfma_f32_16x16x32_bf16 v[52:55], v[64:67], v[40:43], v[52:55]
    v_mfma_f32_16x16x32_bf16 v[52:55], v[68:71], v[44:47], v[52:55]
    v_mfma_f32_16x16x32_bf16 v[52:55], v[72:75], v[48:51], v[52:55]
    v_mfma_f32_16x16x32_bf16 v[56:59], v[76:79], v[36:39], 0
    v_mfma_f32_16x16x32_bf16 v[56:59], v[80:83], v[40:43], v[56:59]
    v_mfma_f32_16x16x32_bf16 v[56:59], v[84:87], v[44:47], v[56:59]
    v_mfma_f32_16x16x32_bf16 v[56:59], v[88:91], v[48:51], v[56:59]
    s_nop 7
    v_cvt_pk_bf16_f32 v26, v52, v53
    v_cvt_pk_bf16_f32 v27, v54, v55
    v_lshlrev_b32 v28, 16, v26
    v_and_b32 v29, 0xffff0000, v26
    v_lshlrev_b32 v30, 16, v27
    v_and_b32 v31, 0xffff0000, v27
    v_mul_f32 v28, s71, v28
    v_mul_f32 v29, s71, v29
    v_mul_f32 v30, s71, v30
    v_mul_f32 v31, s71, v31
    v_max3_f32 v22, v28, v29, v22
    v_max3_f32 v22, v30, v31, v22
    v_cvt_pk_bf16_f32 v60, v28, v29
    v_cvt_pk_bf16_f32 v61, v30, v31
    v_mfma_f32_16x16x32_bf16 v[52:55], v[92:95], v[36:39], 0
    v_mfma_f32_16x16x32_bf16 v[52:55], v[96:99], v[40:43], v[52:55]
    v_mfma_f32_16x16x32_bf16 v[52:55], v[100:103], v[44:47], v[52:55]
    v_mfma_f32_16x16x32_bf16 v[52:55], v[104:107], v[48:51], v[52:55]
    v_cvt_pk_bf16_f32 v26, v56, v57
    v_cvt_pk_bf16_f32 v27, v58, v59
    v_lshlrev_b32 v28, 16, v26
    v_and_b32 v29, 0xffff0000, v26
    v_lshlrev_b32 v30, 16, v27
    v_and_b32 v31, 0xffff0000, v27
    v_mul_f32 v28, s71, v28
    v_mul_f32 v29, s71, v29
    v_mul_f32 v30, s71, v30
    v_mul_f32 v31, s71, v31
    v_max3_f32 v22, v28, v29, v22
    v_max3_f32 v22, v30, v31, v22
    v_cvt_pk_bf16_f32 v62, v28, v29
    v_cvt_pk_bf16_f32 v63, v30, v31
    v_mfma_f32_16x16x32_bf16 v[56:59], v[108:111], v[36:39], 0
    v_mfma_f32_16x16x32_bf16 v[56:59], v[112:115], v[40:43], v[56:59]
    v_mfma_f32_16x16x32_bf16 v[56:59], v[116:119], v[44:47], v[56:59]
    v_mfma_f32_16x16x32_bf16 v[56:59], v[120:123], v[48:51], v[56:59]
    v_cvt_pk_bf16_f32 v26, v52, v53
    v_cvt_pk_bf16_f32 v27, v54, v55
    v_lshlrev_b32 v28, 16, v26
    v_and_b32 v29, 0xffff0000, v26
    v_lshlrev_b32 v30, 16, v27
    v_and_b32 v31, 0xffff0000, v27
    v_mul_f32 v28, s71, v28
    v_mul_f32 v29, s71, v29
    v_mul_f32 v30, s71, v30
    v_mul_f32 v31, s71, v31
    v_max3_f32 v22, v28, v29, v22
    v_max3_f32 v22, v30, v31, v22
    v_cvt_pk_bf16_f32 v64, v28, v29
    v_cvt_pk_bf16_f32 v65, v30, v31
    v_mfma_f32_16x16x32_bf16 v[52:55], v[124:127], v[36:39], 0
    v_mfma_f32_16x16x32_bf16 v[52:55], v[128:131], v[40:43], v[52:55]
    v_mfma_f32_16x16x32_bf16 v[52:55], v[132:135], v[44:47], v[52:55]
    v_mfma_f32_16x16x32_bf16 v[52:55], v[136:139], v[48:51], v[52:55]
    v_cvt_pk_bf16_f32 v26, v56, v57
    v_cvt_pk_bf16_f32 v27, v58, v59
    v_lshlrev_b32 v28, 16, v26
    v_and_b32 v29, 0xffff0000, v26
    v_lshlrev_b32 v30, 16, v27
    v_and_b32 v31, 0xffff0000, v27
    v_mul_f32 v28, s71, v28
    v_mul_f32 v29, s71, v29
    v_mul_f32 v30, s71, v30
    v_mul_f32 v31, s71, v31
    v_max3_f32 v22, v28, v29, v22
    v_max3_f32 v22, v30, v31, v22
    v_cvt_pk_bf16_f32 v66, v28, v29
    v_cvt_pk_bf16_f32 v67, v30, v31
    v_mfma_f32_16x16x32_bf16 v[56:59], v[140:143], v[36:39], 0
    v_mfma_f32_16x16x32_bf16 v[56:59], v[144:147], v[40:43], v[56:59]
    v_mfma_f32_16x16x32_bf16 v[56:59], v[148:151], v[44:47], v[56:59]
    v_mfma_f32_16x16x32_bf16 v[56:59], v[152:155], v[48:51], v[56:59]
    v_cvt_pk_bf16_f32 v26, v52, v53
    v_cvt_pk_bf16_f32 v27, v54, v55
    v_lshlrev_b32 v28, 16, v26
    v_and_b32 v29, 0xffff0000, v26
    v_lshlrev_b32 v30, 16, v27
    v_and_b32 v31, 0xffff0000, v27
    v_mul_f32 v28, s71, v28
    v_mul_f32 v29, s71, v29
    v_mul_f32 v30, s71, v30
    v_mul_f32 v31, s71, v31
    v_max3_f32 v22, v28, v29, v22
    v_max3_f32 v22, v30, v31, v22
    v_cvt_pk_bf16_f32 v68, v28, v29
    v_cvt_pk_bf16_f32 v69, v30, v31
    v_mfma_f32_16x16x32_bf16 v[52:55], v[156:159], v[36:39], 0
    v_mfma_f32_16x16x32_bf16 v[52:55], v[160:163], v[40:43], v[52:55]
    v_mfma_f32_16x16x32_bf16 v[52:55], v[164:167], v[44:47], v[52:55]
    v_mfma_f32_16x16x32_bf16 v[52:55], v[168:171], v[48:51], v[52:55]
    v_cvt_pk_bf16_f32 v26, v56, v57
    v_cvt_pk_bf16_f32 v27, v58, v59
    v_lshlrev_b32 v28, 16, v26
    v_and_b32 v29, 0xffff0000, v26
    v_lshlrev_b32 v30, 16, v27
    v_and_b32 v31, 0xffff0000, v27
    v_mul_f32 v28, s71, v28
    v_mul_f32 v29, s71, v29
    v_mul_f32 v30, s71, v30
    v_mul_f32 v31, s71, v31
    v_max3_f32 v22, v28, v29, v22
    v_max3_f32 v22, v30, v31, v22
    v_cvt_pk_bf16_f32 v70, v28, v29
    v_cvt_pk_bf16_f32 v71, v30, v31
    v_mfma_f32_16x16x32_bf16 v[56:59], v[172:175], v[36:39], 0
    v_mfma_f32_16x16x32_bf16 v[56:59], v[176:179], v[40:43], v[56:59]
    v_mfma_f32_16x16x32_bf16 v[56:59], v[180:183], v[44:47], v[56:59]
    v_mfma_f32_16x16x32_bf16 v[56:59], v[184:187], v[48:51], v[56:59]
    v_cvt_pk_bf16_f32 v26, v52, v53
    v_cvt_pk_bf16_f32 v27, v54, v55
    v_lshlrev_b32 v28, 16, v26
    v_and_b32 v29, 0xffff0000, v26
    v_lshlrev_b32 v30, 16, v27
    v_and_b32 v31, 0xffff0000, v27
    v_mul_f32 v28, s71, v28
    v_mul_f32 v29, s71, v29
    v_mul_f32 v30, s71, v30
    v_mul_f32 v31, s71, v31
    v_max3_f32 v22, v28, v29, v22
    v_max3_f32 v22, v30, v31, v22
    v_cvt_pk_bf16_f32 v72, v28, v29
    v_cvt_pk_bf16_f32 v73, v30, v31
    v_mfma_f32_16x16x32_bf16 v[52:55], v[188:191], v[36:39], 0
    v_mfma_f32_16x16x32_bf16 v[52:55], v[192:195], v[40:43], v[52:55]
    v_mfma_f32_16x16x32_bf16 v[52:55], v[196:199], v[44:47], v[52:55]
    v_mfma_f32_16x16x32_bf16 v[52:55], v[200:203], v[48:51], v[52:55]
    v_cvt_pk_bf16_f32 v26, v56, v57
    v_cvt_pk_bf16_f32 v27, v58, v59
    v_lshlrev_b32 v28, 16, v26
    v_and_b32 v29, 0xffff0000, v26
    v_lshlrev_b32 v30, 16, v27
    v_and_b32 v31, 0xffff0000, v27
    v_mul_f32 v28, s71, v28
    v_mul_f32 v29, s71, v29
    v_mul_f32 v30, s71, v30
    v_mul_f32 v31, s71, v31
    v_max3_f32 v22, v28, v29, v22
    v_max3_f32 v22, v30, v31, v22
    v_cvt_pk_bf16_f32 v74, v28, v29
    v_cvt_pk_bf16_f32 v75, v30, v31
    v_mfma_f32_16x16x32_bf16 v[56:59], v[204:207], v[36:39], 0
    v_mfma_f32_16x16x32_bf16 v[56:59], v[208:211], v[40:43], v[56:59]
    v_mfma_f32_16x16x32_bf16 v[56:59], v[212:215], v[44:47], v[56:59]
    v_mfma_f32_16x16x32_bf16 v[56:59], v[216:219], v[48:51], v[56:59]
    v_cvt_pk_bf16_f32 v26, v52, v53
    v_cvt_pk_bf16_f32 v27, v54, v55
    v_lshlrev_b32 v28, 16, v26
    v_and_b32 v29, 0xffff0000, v26
    v_lshlrev_b32 v30, 16, v27
    v_and_b32 v31, 0xffff0000, v27
    v_mul_f32 v28, s71, v28
    v_mul_f32 v29, s71, v29
    v_mul_f32 v30, s71, v30
    v_mul_f32 v31, s71, v31
    v_max3_f32 v22, v28, v29, v22
    v_max3_f32 v22, v30, v31, v22
    v_cvt_pk_bf16_f32 v76, v28, v29
    v_cvt_pk_bf16_f32 v77, v30, v31
    v_mfma_f32_16x16x32_bf16 v[52:55], v[220:223], v[36:39], 0
    v_mfma_f32_16x16x32_bf16 v[52:55], v[224:227], v[40:43], v[52:55]
    v_mfma_f32_16x16x32_bf16 v[52:55], v[228:231], v[44:47], v[52:55]
    v_mfma_f32_16x16x32_bf16 v[52:55], v[232:235], v[48:51], v[52:55]
    v_cvt_pk_bf16_f32 v26, v56, v57
    v_cvt_pk_bf16_f32 v27, v58, v59
    v_lshlrev_b32 v28, 16, v26
    v_and_b32 v29, 0xffff0000, v26
    v_lshlrev_b32 v30, 16, v27
    v_and_b32 v31, 0xffff0000, v27
    v_mul_f32 v28, s71, v28
    v_mul_f32 v29, s71, v29
    v_mul_f32 v30, s71, v30
    v_mul_f32 v31, s71, v31
    v_max3_f32 v22, v28, v29, v22
    v_max3_f32 v22, v30, v31, v22
    v_cvt_pk_bf16_f32 v78, v28, v29
    v_cvt_pk_bf16_f32 v79, v30, v31
    v_mfma_f32_16x16x32_bf16 v[56:59], v[236:239], v[36:39], 0
    v_mfma_f32_16x16x32_bf16 v[56:59], v[240:243], v[40:43], v[56:59]
    v_mfma_f32_16x16x32_bf16 v[56:59], v[244:247], v[44:47], v[56:59]
    v_mfma_f32_16x16x32_bf16 v[56:59], v[248:251], v[48:51], v[56:59]
    v_cvt_pk_bf16_f32 v26, v52, v53
    v_cvt_pk_bf16_f32 v27, v54, v55
    v_lshlrev_b32 v28, 16, v26
    v_and_b32 v29, 0xffff0000, v26
    v_lshlrev_b32 v30, 16, v27
    v_and_b32 v31, 0xffff0000, v27
    v_mul_f32 v28, s71, v28
    v_mul_f32 v29, s71, v29
    v_mul_f32 v30, s71, v30
    v_mul_f32 v31, s71, v31
    v_max3_f32 v22, v28, v29, v22
    v_max3_f32 v22, v30, v31, v22
    v_cvt_pk_bf16_f32 v80, v28, v29
    v_cvt_pk_bf16_f32 v81, v30, v31
    s_nop 7
    s_nop 1
    v_cvt_pk_bf16_f32 v26, v56, v57
    v_cvt_pk_bf16_f32 v27, v58, v59
    v_lshlrev_b32 v28, 16, v26
    v_and_b32 v29, 0xffff0000, v26
    v_lshlrev_b32 v30, 16, v27
    v_and_b32 v31, 0xffff0000, v27
    v_mul_f32 v28, s71, v28
    v_mul_f32 v29, s71, v29
    v_mul_f32 v30, s71, v30
    v_mul_f32 v31, s71, v31
    v_max3_f32 v22, v28, v29, v22
    v_max3_f32 v22, v30, v31, v22
    v_cvt_pk_bf16_f32 v82, v28, v29
    v_cvt_pk_bf16_f32 v83, v30, v31
    v_mov_b32 v26, v22
    s_nop 1
    v_permlane32_swap_b32 v22, v26
    s_nop 1
    v_max_f32 v22, v22, v26
    v_mov_b32 v26, v22
    s_nop 1
    v_permlane16_swap_b32 v22, v26
    s_nop 1
    v_max_f32 v22, v22, v26
    v_cvt_pk_bf16_f32 v22, v22, v22
    v_and_b32 v22, 0xffff0000, v22
    v_mul_f32 v24, s72, v22
    v_sub_f32 v24, 0, v24
    s_waitcnt vmcnt(8)
    ds_read_b64_tr_b16 v[92:93], v14 offset:0
    ds_read_b64_tr_b16 v[94:95], v14 offset:4096
    ds_read_b64_tr_b16 v[96:97], v15 offset:0
    ds_read_b64_tr_b16 v[98:99], v15 offset:4096
    ds_read_b64_tr_b16 v[100:101], v16 offset:0
    ds_read_b64_tr_b16 v[102:103], v16 offset:4096
    ds_read_b64_tr_b16 v[104:105], v17 offset:0
    ds_read_b64_tr_b16 v[106:107], v17 offset:4096
    ds_read_b64_tr_b16 v[108:109], v18 offset:0
    ds_read_b64_tr_b16 v[110:111], v18 offset:4096
    ds_read_b64_tr_b16 v[112:113], v19 offset:0
    ds_read_b64_tr_b16 v[114:115], v19 offset:4096
    ds_read_b64_tr_b16 v[116:117], v20 offset:0
    ds_read_b64_tr_b16 v[118:119], v20 offset:4096
    ds_read_b64_tr_b16 v[120:121], v21 offset:0
    ds_read_b64_tr_b16 v[122:123], v21 offset:4096
    v_lshlrev_b32 v26, 16, v60
    v_and_b32 v27, 0xffff0000, v60
    v_fma_f32 v26, v26, s72, v24
    v_fma_f32 v27, v27, s72, v24
    v_exp_f32 v26, v26
    v_exp_f32 v27, v27
    s_nop 0
    v_add_f32 v23, v23, v26
    v_cvt_pk_bf16_f32 v60, v26, v27
    v_add_f32 v23, v23, v27
    v_lshlrev_b32 v26, 16, v61
    v_and_b32 v27, 0xffff0000, v61
    v_fma_f32 v26, v26, s72, v24
    v_fma_f32 v27, v27, s72, v24
    v_exp_f32 v26, v26
    v_exp_f32 v27, v27
    s_nop 0
    v_add_f32 v23, v23, v26
    v_cvt_pk_bf16_f32 v61, v26, v27
    v_add_f32 v23, v23, v27
    v_lshlrev_b32 v26, 16, v62
    v_and_b32 v27, 0xffff0000, v62
    v_fma_f32 v26, v26, s72, v24
    v_fma_f32 v27, v27, s72, v24
    v_exp_f32 v26, v26
    v_exp_f32 v27, v27
    s_nop 0
    v_add_f32 v23, v23, v26
    v_cvt_pk_bf16_f32 v62, v26, v27
    v_add_f32 v23, v23, v27
    v_lshlrev_b32 v26, 16, v63
    v_and_b32 v27, 0xffff0000, v63
    v_fma_f32 v26, v26, s72, v24
    v_fma_f32 v27, v27, s72, v24
    v_exp_f32 v26, v26
    v_exp_f32 v27, v27
    s_nop 0
    v_add_f32 v23, v23, v26
    v_cvt_pk_bf16_f32 v63, v26, v27
    v_add_f32 v23, v23, v27
    s_waitcnt lgkmcnt(0)
    s_add_u32 s69, s80, 262144
    s_and_b32 s69, s69, 0x3fffff
    s_or_b32 s69, s69, s78
    s_add_u32 m0, s70, 0
    s_nop 0
    buffer_load_dwordx4 v8, s[44:47], s69 offen offset:0 nt lds
    buffer_load_dwordx4 v9, s[44:47], s69 offen offset:1024 nt lds
    buffer_load_dwordx4 v8, s[44:47], s69 offen offset:2048 nt lds
    buffer_load_dwordx4 v9, s[44:47], s69 offen offset:3072 nt lds
    s_add_u32 s69, s80, 2359296
    s_and_b32 s69, s69, 0x3fffff
    s_or_b32 s69, s69, s78
    s_add_u32 m0, s70, 4096
    s_nop 0
    buffer_load_dwordx4 v8, s[44:47], s69 offen offset:0 nt lds
    buffer_load_dwordx4 v9, s[44:47], s69 offen offset:1024 nt lds
    buffer_load_dwordx4 v8, s[44:47], s69 offen offset:2048 nt lds
    buffer_load_dwordx4 v9, s[44:47], s69 offen offset:3072 nt lds
    s_nop 1
    v_mfma_f32_16x16x32_bf16 v[124:127], v[92:95], v[60:63], 0
    v_mfma_f32_16x16x32_bf16 v[128:131], v[96:99], v[60:63], 0
    v_mfma_f32_16x16x32_bf16 v[132:135], v[100:103], v[60:63], 0
    v_mfma_f32_16x16x32_bf16 v[136:139], v[104:107], v[60:63], 0
    v_mfma_f32_16x16x32_bf16 v[140:143], v[108:111], v[60:63], 0
    v_mfma_f32_16x16x32_bf16 v[144:147], v[112:115], v[60:63], 0
    v_mfma_f32_16x16x32_bf16 v[148:151], v[116:119], v[60:63], 0
    v_mfma_f32_16x16x32_bf16 v[152:155], v[120:123], v[60:63], 0
    s_waitcnt vmcnt(8)
    ds_read_b64_tr_b16 v[92:93], v14 offset:8192
    ds_read_b64_tr_b16 v[94:95], v14 offset:12288
    ds_read_b64_tr_b16 v[96:97], v15 offset:8192
    ds_read_b64_tr_b16 v[98:99], v15 offset:12288
    ds_read_b64_tr_b16 v[100:101], v16 offset:8192
    ds_read_b64_tr_b16 v[102:103], v16 offset:12288
    ds_read_b64_tr_b16 v[104:105], v17 offset:8192
    ds_read_b64_tr_b16 v[106:107], v17 offset:12288
    ds_read_b64_tr_b16 v[108:109], v18 offset:8192
    ds_read_b64_tr_b16 v[110:111], v18 offset:12288
    ds_read_b64_tr_b16 v[112:113], v19 offset:8192
    ds_read_b64_tr_b16 v[114:115], v19 offset:12288
    ds_read_b64_tr_b16 v[116:117], v20 offset:8192
    ds_read_b64_tr_b16 v[118:119], v20 offset:12288
    ds_read_b64_tr_b16 v[120:121], v21 offset:8192
    ds_read_b64_tr_b16 v[122:123], v21 offset:12288
    v_lshlrev_b32 v26, 16, v64
    v_and_b32 v27, 0xffff0000, v64
    v_fma_f32 v26, v26, s72, v24
    v_fma_f32 v27, v27, s72, v24
    v_exp_f32 v26, v26
    v_exp_f32 v27, v27
    s_nop 0
    v_add_f32 v23, v23, v26
    v_cvt_pk_bf16_f32 v64, v26, v27
    v_add_f32 v23, v23, v27
    v_lshlrev_b32 v26, 16, v65
    v_and_b32 v27, 0xffff0000, v65
    v_fma_f32 v26, v26, s72, v24
    v_fma_f32 v27, v27, s72, v24
    v_exp_f32 v26, v26
    v_exp_f32 v27, v27
    s_nop 0
    v_add_f32 v23, v23, v26
    v_cvt_pk_bf16_f32 v65, v26, v27
    v_add_f32 v23, v23, v27
    v_lshlrev_b32 v26, 16, v66
    v_and_b32 v27, 0xffff0000, v66
    v_fma_f32 v26, v26, s72, v24
    v_fma_f32 v27, v27, s72, v24
    v_exp_f32 v26, v26
    v_exp_f32 v27, v27
    s_nop 0
    v_add_f32 v23, v23, v26
    v_cvt_pk_bf16_f32 v66, v26, v27
    v_add_f32 v23, v23, v27
    v_lshlrev_b32 v26, 16, v67
    v_and_b32 v27, 0xffff0000, v67
    v_fma_f32 v26, v26, s72, v24
    v_fma_f32 v27, v27, s72, v24
    v_exp_f32 v26, v26
    v_exp_f32 v27, v27
    s_nop 0
    v_add_f32 v23, v23, v26
    v_cvt_pk_bf16_f32 v67, v26, v27
    v_add_f32 v23, v23, v27
    s_waitcnt lgkmcnt(0)
    s_add_u32 s69, s80, 393216
    s_and_b32 s69, s69, 0x3fffff
    s_or_b32 s69, s69, s78
    s_add_u32 m0, s70, 8192
    s_nop 0
    buffer_load_dwordx4 v8, s[44:47], s69 offen offset:0 nt lds
    buffer_load_dwordx4 v9, s[44:47], s69 offen offset:1024 nt lds
    buffer_load_dwordx4 v8, s[44:47], s69 offen offset:2048 nt lds
    buffer_load_dwordx4 v9, s[44:47], s69 offen offset:3072 nt lds
    s_add_u32 s69, s80, 2490368
    s_and_b32 s69, s69, 0x3fffff
    s_or_b32 s69, s69, s78
    s_add_u32 m0, s70, 12288
    s_nop 0
    buffer_load_dwordx4 v8, s[44:47], s69 offen offset:0 nt lds
    buffer_load_dwordx4 v9, s[44:47], s69 offen offset:1024 nt lds
    buffer_load_dwordx4 v8, s[44:47], s69 offen offset:2048 nt lds
    buffer_load_dwordx4 v9, s[44:47], s69 offen offset:3072 nt lds
    s_nop 1
    v_mfma_f32_16x16x32_bf16 v[124:127], v[92:95], v[64:67], v[124:127]
    v_mfma_f32_16x16x32_bf16 v[128:131], v[96:99], v[64:67], v[128:131]
    v_mfma_f32_16x16x32_bf16 v[132:135], v[100:103], v[64:67], v[132:135]
    v_mfma_f32_16x16x32_bf16 v[136:139], v[104:107], v[64:67], v[136:139]
    v_mfma_f32_16x16x32_bf16 v[140:143], v[108:111], v[64:67], v[140:143]
    v_mfma_f32_16x16x32_bf16 v[144:147], v[112:115], v[64:67], v[144:147]
    v_mfma_f32_16x16x32_bf16 v[148:151], v[116:119], v[64:67], v[148:151]
    v_mfma_f32_16x16x32_bf16 v[152:155], v[120:123], v[64:67], v[152:155]
    s_waitcnt vmcnt(8)
    ds_read_b64_tr_b16 v[92:93], v14 offset:0
    ds_read_b64_tr_b16 v[94:95], v14 offset:4096
    ds_read_b64_tr_b16 v[96:97], v15 offset:0
    ds_read_b64_tr_b16 v[98:99], v15 offset:4096
    ds_read_b64_tr_b16 v[100:101], v16 offset:0
    ds_read_b64_tr_b16 v[102:103], v16 offset:4096
    ds_read_b64_tr_b16 v[104:105], v17 offset:0
    ds_read_b64_tr_b16 v[106:107], v17 offset:4096
    ds_read_b64_tr_b16 v[108:109], v18 offset:0
    ds_read_b64_tr_b16 v[110:111], v18 offset:4096
    ds_read_b64_tr_b16 v[112:113], v19 offset:0
    ds_read_b64_tr_b16 v[114:115], v19 offset:4096
    ds_read_b64_tr_b16 v[116:117], v20 offset:0
    ds_read_b64_tr_b16 v[118:119], v20 offset:4096
    ds_read_b64_tr_b16 v[120:121], v21 offset:0
    ds_read_b64_tr_b16 v[122:123], v21 offset:4096
    v_lshlrev_b32 v26, 16, v68
    v_and_b32 v27, 0xffff0000, v68
    v_fma_f32 v26, v26, s72, v24
    v_fma_f32 v27, v27, s72, v24
    v_exp_f32 v26, v26
    v_exp_f32 v27, v27
    s_nop 0
    v_add_f32 v23, v23, v26
    v_cvt_pk_bf16_f32 v68, v26, v27
    v_add_f32 v23, v23, v27
    v_lshlrev_b32 v26, 16, v69
    v_and_b32 v27, 0xffff0000, v69
    v_fma_f32 v26, v26, s72, v24
    v_fma_f32 v27, v27, s72, v24
    v_exp_f32 v26, v26
    v_exp_f32 v27, v27
    s_nop 0
    v_add_f32 v23, v23, v26
    v_cvt_pk_bf16_f32 v69, v26, v27
    v_add_f32 v23, v23, v27
    v_lshlrev_b32 v26, 16, v70
    v_and_b32 v27, 0xffff0000, v70
    v_fma_f32 v26, v26, s72, v24
    v_fma_f32 v27, v27, s72, v24
    v_exp_f32 v26, v26
    v_exp_f32 v27, v27
    s_nop 0
    v_add_f32 v23, v23, v26
    v_cvt_pk_bf16_f32 v70, v26, v27
    v_add_f32 v23, v23, v27
    v_lshlrev_b32 v26, 16, v71
    v_and_b32 v27, 0xffff0000, v71
    v_fma_f32 v26, v26, s72, v24
    v_fma_f32 v27, v27, s72, v24
    v_exp_f32 v26, v26
    v_exp_f32 v27, v27
    s_nop 0
    v_add_f32 v23, v23, v26
    v_cvt_pk_bf16_f32 v71, v26, v27
    v_add_f32 v23, v23, v27
    s_waitcnt lgkmcnt(0)
    s_add_u32 s69, s80, 524288
    s_and_b32 s69, s69, 0x3fffff
    s_or_b32 s69, s69, s78
    s_add_u32 m0, s70, 0
    s_nop 0
    buffer_load_dwordx4 v8, s[44:47], s69 offen offset:0 nt lds
    buffer_load_dwordx4 v9, s[44:47], s69 offen offset:1024 nt lds
    buffer_load_dwordx4 v8, s[44:47], s69 offen offset:2048 nt lds
    buffer_load_dwordx4 v9, s[44:47], s69 offen offset:3072 nt lds
    s_add_u32 s69, s80, 2621440
    s_and_b32 s69, s69, 0x3fffff
    s_or_b32 s69, s69, s78
    s_add_u32 m0, s70, 4096
    s_nop 0
    buffer_load_dwordx4 v8, s[44:47], s69 offen offset:0 nt lds
    buffer_load_dwordx4 v9, s[44:47], s69 offen offset:1024 nt lds
    buffer_load_dwordx4 v8, s[44:47], s69 offen offset:2048 nt lds
    buffer_load_dwordx4 v9, s[44:47], s69 offen offset:3072 nt lds
    s_nop 1
    v_mfma_f32_16x16x32_bf16 v[124:127], v[92:95], v[68:71], v[124:127]
    v_mfma_f32_16x16x32_bf16 v[128:131], v[96:99], v[68:71], v[128:131]
    v_mfma_f32_16x16x32_bf16 v[132:135], v[100:103], v[68:71], v[132:135]
    v_mfma_f32_16x16x32_bf16 v[136:139], v[104:107], v[68:71], v[136:139]
    v_mfma_f32_16x16x32_bf16 v[140:143], v[108:111], v[68:71], v[140:143]
    v_mfma_f32_16x16x32_bf16 v[144:147], v[112:115], v[68:71], v[144:147]
    v_mfma_f32_16x16x32_bf16 v[148:151], v[116:119], v[68:71], v[148:151]
    v_mfma_f32_16x16x32_bf16 v[152:155], v[120:123], v[68:71], v[152:155]
    s_waitcnt vmcnt(8)
    ds_read_b64_tr_b16 v[92:93], v14 offset:8192
    ds_read_b64_tr_b16 v[94:95], v14 offset:12288
    ds_read_b64_tr_b16 v[96:97], v15 offset:8192
    ds_read_b64_tr_b16 v[98:99], v15 offset:12288
    ds_read_b64_tr_b16 v[100:101], v16 offset:8192
    ds_read_b64_tr_b16 v[102:103], v16 offset:12288
    ds_read_b64_tr_b16 v[104:105], v17 offset:8192
    ds_read_b64_tr_b16 v[106:107], v17 offset:12288
    ds_read_b64_tr_b16 v[108:109], v18 offset:8192
    ds_read_b64_tr_b16 v[110:111], v18 offset:12288
    ds_read_b64_tr_b16 v[112:113], v19 offset:8192
    ds_read_b64_tr_b16 v[114:115], v19 offset:12288
    ds_read_b64_tr_b16 v[116:117], v20 offset:8192
    ds_read_b64_tr_b16 v[118:119], v20 offset:12288
    ds_read_b64_tr_b16 v[120:121], v21 offset:8192
    ds_read_b64_tr_b16 v[122:123], v21 offset:12288
    v_lshlrev_b32 v26, 16, v72
    v_and_b32 v27, 0xffff0000, v72
    v_fma_f32 v26, v26, s72, v24
    v_fma_f32 v27, v27, s72, v24
    v_exp_f32 v26, v26
    v_exp_f32 v27, v27
    s_nop 0
    v_add_f32 v23, v23, v26
    v_cvt_pk_bf16_f32 v72, v26, v27
    v_add_f32 v23, v23, v27
    v_lshlrev_b32 v26, 16, v73
    v_and_b32 v27, 0xffff0000, v73
    v_fma_f32 v26, v26, s72, v24
    v_fma_f32 v27, v27, s72, v24
    v_exp_f32 v26, v26
    v_exp_f32 v27, v27
    s_nop 0
    v_add_f32 v23, v23, v26
    v_cvt_pk_bf16_f32 v73, v26, v27
    v_add_f32 v23, v23, v27
    v_lshlrev_b32 v26, 16, v74
    v_and_b32 v27, 0xffff0000, v74
    v_fma_f32 v26, v26, s72, v24
    v_fma_f32 v27, v27, s72, v24
    v_exp_f32 v26, v26
    v_exp_f32 v27, v27
    s_nop 0
    v_add_f32 v23, v23, v26
    v_cvt_pk_bf16_f32 v74, v26, v27
    v_add_f32 v23, v23, v27
    v_lshlrev_b32 v26, 16, v75
    v_and_b32 v27, 0xffff0000, v75
    v_fma_f32 v26, v26, s72, v24
    v_fma_f32 v27, v27, s72, v24
    v_exp_f32 v26, v26
    v_exp_f32 v27, v27
    s_nop 0
    v_add_f32 v23, v23, v26
    v_cvt_pk_bf16_f32 v75, v26, v27
    v_add_f32 v23, v23, v27
    s_waitcnt lgkmcnt(0)
    s_add_u32 s69, s80, 655360
    s_and_b32 s69, s69, 0x3fffff
    s_or_b32 s69, s69, s78
    s_add_u32 m0, s70, 8192
    s_nop 0
    buffer_load_dwordx4 v8, s[44:47], s69 offen offset:0 nt lds
    buffer_load_dwordx4 v9, s[44:47], s69 offen offset:1024 nt lds
    buffer_load_dwordx4 v8, s[44:47], s69 offen offset:2048 nt lds
    buffer_load_dwordx4 v9, s[44:47], s69 offen offset:3072 nt lds
    s_add_u32 s69, s80, 2752512
    s_and_b32 s69, s69, 0x3fffff
    s_or_b32 s69, s69, s78
    s_add_u32 m0, s70, 12288
    s_nop 0
    buffer_load_dwordx4 v8, s[44:47], s69 offen offset:0 nt lds
    buffer_load_dwordx4 v9, s[44:47], s69 offen offset:1024 nt lds
    buffer_load_dwordx4 v8, s[44:47], s69 offen offset:2048 nt lds
    buffer_load_dwordx4 v9, s[44:47], s69 offen offset:3072 nt lds
    s_nop 1
    v_mfma_f32_16x16x32_bf16 v[124:127], v[92:95], v[72:75], v[124:127]
    v_mfma_f32_16x16x32_bf16 v[128:131], v[96:99], v[72:75], v[128:131]
    v_mfma_f32_16x16x32_bf16 v[132:135], v[100:103], v[72:75], v[132:135]
    v_mfma_f32_16x16x32_bf16 v[136:139], v[104:107], v[72:75], v[136:139]
    v_mfma_f32_16x16x32_bf16 v[140:143], v[108:111], v[72:75], v[140:143]
    v_mfma_f32_16x16x32_bf16 v[144:147], v[112:115], v[72:75], v[144:147]
    v_mfma_f32_16x16x32_bf16 v[148:151], v[116:119], v[72:75], v[148:151]
    v_mfma_f32_16x16x32_bf16 v[152:155], v[120:123], v[72:75], v[152:155]
    s_waitcnt vmcnt(8)
    ds_read_b64_tr_b16 v[92:93], v14 offset:0
    ds_read_b64_tr_b16 v[94:95], v14 offset:4096
    ds_read_b64_tr_b16 v[96:97], v15 offset:0
    ds_read_b64_tr_b16 v[98:99], v15 offset:4096
    ds_read_b64_tr_b16 v[100:101], v16 offset:0
    ds_read_b64_tr_b16 v[102:103], v16 offset:4096
    ds_read_b64_tr_b16 v[104:105], v17 offset:0
    ds_read_b64_tr_b16 v[106:107], v17 offset:4096
    ds_read_b64_tr_b16 v[108:109], v18 offset:0
    ds_read_b64_tr_b16 v[110:111], v18 offset:4096
    ds_read_b64_tr_b16 v[112:113], v19 offset:0
    ds_read_b64_tr_b16 v[114:115], v19 offset:4096
    ds_read_b64_tr_b16 v[116:117], v20 offset:0
    ds_read_b64_tr_b16 v[118:119], v20 offset:4096
    ds_read_b64_tr_b16 v[120:121], v21 offset:0
    ds_read_b64_tr_b16 v[122:123], v21 offset:4096
    v_lshlrev_b32 v26, 16, v76
    v_and_b32 v27, 0xffff0000, v76
    v_fma_f32 v26, v26, s72, v24
    v_fma_f32 v27, v27, s72, v24
    v_exp_f32 v26, v26
    v_exp_f32 v27, v27
    s_nop 0
    v_add_f32 v23, v23, v26
    v_cvt_pk_bf16_f32 v76, v26, v27
    v_add_f32 v23, v23, v27
    v_lshlrev_b32 v26, 16, v77
    v_and_b32 v27, 0xffff0000, v77
    v_fma_f32 v26, v26, s72, v24
    v_fma_f32 v27, v27, s72, v24
    v_exp_f32 v26, v26
    v_exp_f32 v27, v27
    s_nop 0
    v_add_f32 v23, v23, v26
    v_cvt_pk_bf16_f32 v77, v26, v27
    v_add_f32 v23, v23, v27
    v_lshlrev_b32 v26, 16, v78
    v_and_b32 v27, 0xffff0000, v78
    v_fma_f32 v26, v26, s72, v24
    v_fma_f32 v27, v27, s72, v24
    v_exp_f32 v26, v26
    v_exp_f32 v27, v27
    s_nop 0
    v_add_f32 v23, v23, v26
    v_cvt_pk_bf16_f32 v78, v26, v27
    v_add_f32 v23, v23, v27
    v_lshlrev_b32 v26, 16, v79
    v_and_b32 v27, 0xffff0000, v79
    v_fma_f32 v26, v26, s72, v24
    v_fma_f32 v27, v27, s72, v24
    v_exp_f32 v26, v26
    v_exp_f32 v27, v27
    s_nop 0
    v_add_f32 v23, v23, v26
    v_cvt_pk_bf16_f32 v79, v26, v27
    v_add_f32 v23, v23, v27
    s_waitcnt lgkmcnt(0)
    s_add_u32 s69, s80, 786432
    s_and_b32 s69, s69, 0x3fffff
    s_or_b32 s69, s69, s78
    s_add_u32 m0, s70, 0
    s_nop 0
    buffer_load_dwordx4 v4, s[40:43], s69 offen offset:0 nt lds
    buffer_load_dwordx4 v5, s[40:43], s69 offen offset:1024 nt lds
    buffer_load_dwordx4 v6, s[40:43], s69 offen offset:2048 nt lds
    buffer_load_dwordx4 v7, s[40:43], s69 offen offset:3072 nt lds
    s_add_u32 s69, s80, 2883584
    s_and_b32 s69, s69, 0x3fffff
    s_or_b32 s69, s69, s78
    s_add_u32 m0, s70, 4096
    s_nop 0
    buffer_load_dwordx4 v4, s[40:43], s69 offen offset:0 nt lds
    buffer_load_dwordx4 v5, s[40:43], s69 offen offset:1024 nt lds
    buffer_load_dwordx4 v6, s[40:43], s69 offen offset:2048 nt lds
    buffer_load_dwordx4 v7, s[40:43], s69 offen offset:3072 nt lds
    s_nop 1
    v_mfma_f32_16x16x32_bf16 v[124:127], v[92:95], v[76:79], v[124:127]
    v_mfma_f32_16x16x32_bf16 v[128:131], v[96:99], v[76:79], v[128:131]
    v_mfma_f32_16x16x32_bf16 v[132:135], v[100:103], v[76:79], v[132:135]
    v_mfma_f32_16x16x32_bf16 v[136:139], v[104:107], v[76:79], v[136:139]
    v_mfma_f32_16x16x32_bf16 v[140:143], v[108:111], v[76:79], v[140:143]
    v_mfma_f32_16x16x32_bf16 v[144:147], v[112:115], v[76:79], v[144:147]
    v_mfma_f32_16x16x32_bf16 v[148:151], v[116:119], v[76:79], v[148:151]
    v_mfma_f32_16x16x32_bf16 v[152:155], v[120:123], v[76:79], v[152:155]
    s_waitcnt vmcnt(8)
    ds_read_b64_tr_b16 v[92:93], v14 offset:8192
    ds_read_b64_tr_b16 v[94:95], v14 offset:12288
    ds_read_b64_tr_b16 v[96:97], v15 offset:8192
    ds_read_b64_tr_b16 v[98:99], v15 offset:12288
    ds_read_b64_tr_b16 v[100:101], v16 offset:8192
    ds_read_b64_tr_b16 v[102:103], v16 offset:12288
    ds_read_b64_tr_b16 v[104:105], v17 offset:8192
    ds_read_b64_tr_b16 v[106:107], v17 offset:12288
    ds_read_b64_tr_b16 v[108:109], v18 offset:8192
    ds_read_b64_tr_b16 v[110:111], v18 offset:12288
    ds_read_b64_tr_b16 v[112:113], v19 offset:8192
    ds_read_b64_tr_b16 v[114:115], v19 offset:12288
    ds_read_b64_tr_b16 v[116:117], v20 offset:8192
    ds_read_b64_tr_b16 v[118:119], v20 offset:12288
    ds_read_b64_tr_b16 v[120:121], v21 offset:8192
    ds_read_b64_tr_b16 v[122:123], v21 offset:12288
    v_lshlrev_b32 v26, 16, v80
    v_and_b32 v27, 0xffff0000, v80
    v_fma_f32 v26, v26, s72, v24
    v_fma_f32 v27, v27, s72, v24
    v_exp_f32 v26, v26
    v_exp_f32 v27, v27
    s_nop 0
    v_add_f32 v23, v23, v26
    v_cvt_pk_bf16_f32 v80, v26, v27
    v_add_f32 v23, v23, v27
    v_lshlrev_b32 v26, 16, v81
    v_and_b32 v27, 0xffff0000, v81
    v_fma_f32 v26, v26, s72, v24
    v_fma_f32 v27, v27, s72, v24
    v_exp_f32 v26, v26
    v_exp_f32 v27, v27
    s_nop 0
    v_add_f32 v23, v23, v26
    v_cvt_pk_bf16_f32 v81, v26, v27
    v_add_f32 v23, v23, v27
    v_lshlrev_b32 v26, 16, v82
    v_and_b32 v27, 0xffff0000, v82
    v_fma_f32 v26, v26, s72, v24
    v_fma_f32 v27, v27, s72, v24
    v_exp_f32 v26, v26
    v_exp_f32 v27, v27
    s_nop 0
    v_add_f32 v23, v23, v26
    v_cvt_pk_bf16_f32 v82, v26, v27
    v_add_f32 v23, v23, v27
    v_lshlrev_b32 v26, 16, v83
    v_and_b32 v27, 0xffff0000, v83
    v_fma_f32 v26, v26, s72, v24
    v_fma_f32 v27, v27, s72, v24
    v_exp_f32 v26, v26
    v_exp_f32 v27, v27
    s_nop 0
    v_add_f32 v23, v23, v26
    v_cvt_pk_bf16_f32 v83, v26, v27
    v_add_f32 v23, v23, v27
    s_waitcnt lgkmcnt(0)
    s_add_u32 s69, s80, 786432
    s_and_b32 s69, s69, 0x3fffff
    s_or_b32 s69, s69, s78
    s_add_u32 m0, s70, 8192
    s_nop 0
    buffer_load_dwordx4 v8, s[44:47], s69 offen offset:0 nt lds
    buffer_load_dwordx4 v9, s[44:47], s69 offen offset:1024 nt lds
    buffer_load_dwordx4 v8, s[44:47], s69 offen offset:2048 nt lds
    buffer_load_dwordx4 v9, s[44:47], s69 offen offset:3072 nt lds
    s_add_u32 s69, s80, 2883584
    s_and_b32 s69, s69, 0x3fffff
    s_or_b32 s69, s69, s78
    s_add_u32 m0, s70, 12288
    s_nop 0
    buffer_load_dwordx4 v8, s[44:47], s69 offen offset:0 nt lds
    buffer_load_dwordx4 v9, s[44:47], s69 offen offset:1024 nt lds
    buffer_load_dwordx4 v8, s[44:47], s69 offen offset:2048 nt lds
    buffer_load_dwordx4 v9, s[44:47], s69 offen offset:3072 nt lds
    s_nop 1
    v_mfma_f32_16x16x32_bf16 v[124:127], v[92:95], v[80:83], v[124:127]
    v_mfma_f32_16x16x32_bf16 v[128:131], v[96:99], v[80:83], v[128:131]
    v_mfma_f32_16x16x32_bf16 v[132:135], v[100:103], v[80:83], v[132:135]
    v_mfma_f32_16x16x32_bf16 v[136:139], v[104:107], v[80:83], v[136:139]
    v_mfma_f32_16x16x32_bf16 v[140:143], v[108:111], v[80:83], v[140:143]
    v_mfma_f32_16x16x32_bf16 v[144:147], v[112:115], v[80:83], v[144:147]
    v_mfma_f32_16x16x32_bf16 v[148:151], v[116:119], v[80:83], v[148:151]
    v_mfma_f32_16x16x32_bf16 v[152:155], v[120:123], v[80:83], v[152:155]
    v_mov_b32 v252, 1
L_unit:
    s_waitcnt vmcnt(12)
    ds_read_b128 v[156:159], v10 offset:0
    ds_read_b128 v[160:163], v11 offset:0
    ds_read_b128 v[164:167], v12 offset:0
    ds_read_b128 v[168:171], v13 offset:0
    v_readfirstlane_b32 s81, v25
    s_add_u32 s81, s81, 256
    s_cmp_ge_u32 s81, 512
    s_cbranch_scc1 L_lastunit
    s_lshl_b32 s81, s81, 12
    s_add_u32 s81, s81, s83
    s_and_b32 s81, s81, 0x3fffff
    s_or_b32 s81, s81, s78
    v_mov_b32 v25, 1
    s_mov_b64 exec, 1
    buffer_atomic_add v25, v253, s[48:51], s82 offen sc0 sc1
    s_mov_b64 exec, -1
    s_waitcnt lgkmcnt(0)
    s_add_u32 m0, s70, 0
    s_nop 0
    buffer_load_dwordx4 v4, s[40:43], s81 offen offset:0 nt lds
    buffer_load_dwordx4 v5, s[40:43], s81 offen offset:1024 nt lds
    buffer_load_dwordx4 v6, s[40:43], s81 offen offset:2048 nt lds
    buffer_load_dwordx4 v7, s[40:43], s81 offen offset:3072 nt lds
    v_mfma_f32_16x16x32_bf16 v[52:55], v[156:159], v[36:39], 0
    v_mfma_f32_16x16x32_bf16 v[52:55], v[160:163], v[40:43], v[52:55]
    v_mfma_f32_16x16x32_bf16 v[52:55], v[164:167], v[44:47], v[52:55]
    v_mfma_f32_16x16x32_bf16 v[52:55], v[168:171], v[48:51], v[52:55]
    s_waitcnt vmcnt(13)
    ds_read_b128 v[172:175], v10 offset:4096
    ds_read_b128 v[176:179], v11 offset:4096
    ds_read_b128 v[180:183], v12 offset:4096
    ds_read_b128 v[184:187], v13 offset:4096
    s_nop 3
    v_cvt_pk_bf16_f32 v26, v52, v53
    v_cvt_pk_bf16_f32 v27, v54, v55
    v_lshlrev_b32 v188, 16, v26
    v_and_b32 v189, 0xffff0000, v26
    v_lshlrev_b32 v190, 16, v27
    v_and_b32 v191, 0xffff0000, v27
    v_mul_f32 v188, s71, v188
    v_mul_f32 v189, s71, v189
    v_mul_f32 v190, s71, v190
    v_mul_f32 v191, s71, v191
    s_waitcnt lgkmcnt(0)
    s_xor_b32 s69, s81, 0x200000
    s_add_u32 m0, s70, 4096
    s_nop 0
    buffer_load_dwordx4 v4, s[40:43], s69 offen offset:0 nt lds
    buffer_load_dwordx4 v5, s[40:43], s69 offen offset:1024 nt lds
    buffer_load_dwordx4 v6, s[40:43], s69 offen offset:2048 nt lds
    buffer_load_dwordx4 v7, s[40:43], s69 offen offset:3072 nt lds
    v_mfma_f32_16x16x32_bf16 v[56:59], v[172:175], v[36:39], 0
    v_mfma_f32_16x16x32_bf16 v[56:59], v[176:179], v[40:43], v[56:59]
    v_mfma_f32_16x16x32_bf16 v[56:59], v[180:183], v[44:47], v[56:59]
    v_mfma_f32_16x16x32_bf16 v[56:59], v[184:187], v[48:51], v[56:59]
    v_cvt_pk_bf16_f32 v200, v188, v189
    v_cvt_pk_bf16_f32 v201, v190, v191
    v_max3_f32 v196, v188, v189, v190
    v_max_f32 v196, v196, v191
    s_nop 5
    v_cvt_pk_bf16_f32 v26, v56, v57
    v_cvt_pk_bf16_f32 v27, v58, v59
    v_lshlrev_b32 v192, 16, v26
    v_and_b32 v193, 0xffff0000, v26
    v_lshlrev_b32 v194, 16, v27
    v_and_b32 v195, 0xffff0000, v27
    v_mul_f32 v192, s71, v192
    v_mul_f32 v193, s71, v193
    v_mul_f32 v194, s71, v194
    v_mul_f32 v195, s71, v195
    v_cvt_pk_bf16_f32 v202, v192, v193
    v_cvt_pk_bf16_f32 v203, v194, v195
    v_max3_f32 v196, v196, v192, v193
    v_max3_f32 v196, v196, v194, v195
    v_mov_b32 v26, v196
    s_nop 1
    v_permlane32_swap_b32 v196, v26
    s_nop 1
    v_max_f32 v196, v196, v26
    v_mov_b32 v26, v196
    s_nop 1
    v_permlane16_swap_b32 v196, v26
    s_nop 1
    v_max_f32 v196, v196, v26
    v_cvt_pk_bf16_f32 v196, v196, v196
    v_and_b32 v196, 0xffff0000, v196
    v_cmp_gt_f32 vcc, v196, v22
    s_cbranch_vccz L_norescale_1
    v_max_f32 v196, v196, v22
    v_sub_f32 v26, v22, v196
    v_mul_f32 v26, s72, v26
    v_exp_f32 v26, v26
    v_mov_b32 v22, v196
    v_mul_f32 v24, s72, v22
    v_sub_f32 v24, 0, v24
    v_mul_f32 v23, v23, v26
    v_mul_f32 v124, v124, v26
    v_mul_f32 v125, v125, v26
    v_mul_f32 v126, v126, v26
    v_mul_f32 v127, v127, v26
    v_mul_f32 v128, v128, v26
    v_mul_f32 v129, v129, v26
    v_mul_f32 v130, v130, v26
    v_mul_f32 v131, v131, v26
    v_mul_f32 v132, v132, v26
    v_mul_f32 v133, v133, v26
    v_mul_f32 v134, v134, v26
    v_mul_f32 v135, v135, v26
    v_mul_f32 v136, v136, v26
    v_mul_f32 v137, v137, v26
    v_mul_f32 v138, v138, v26
    v_mul_f32 v139, v139, v26
    v_mul_f32 v140, v140, v26
    v_mul_f32 v141, v141, v26
    v_mul_f32 v142, v142, v26
    v_mul_f32 v143, v143, v26
    v_mul_f32 v144, v144, v26
    v_mul_f32 v145, v145, v26
    v_mul_f32 v146, v146, v26
    v_mul_f32 v147, v147, v26
    v_mul_f32 v148, v148, v26
    v_mul_f32 v149, v149, v26
    v_mul_f32 v150, v150, v26
    v_mul_f32 v151, v151, v26
    v_mul_f32 v152, v152, v26
    v_mul_f32 v153, v153, v26
    v_mul_f32 v154, v154, v26
    v_mul_f32 v155, v155, v26
L_norescale_1:
    s_waitcnt vmcnt(13)
    ds_read_b64_tr_b16 v[92:93], v14 offset:8192
    ds_read_b64_tr_b16 v[96:97], v15 offset:8192
    ds_read_b64_tr_b16 v[100:101], v16 offset:8192
    ds_read_b64_tr_b16 v[104:105], v17 offset:8192
    ds_read_b64_tr_b16 v[108:109], v18 offset:8192
    ds_read_b64_tr_b16 v[112:113], v19 offset:8192
    ds_read_b64_tr_b16 v[116:117], v20 offset:8192
    ds_read_b64_tr_b16 v[120:121], v21 offset:8192
    v_lshlrev_b32 v26, 16, v200
    v_and_b32 v27, 0xffff0000, v200
    v_fma_f32 v26, v26, s72, v24
    v_fma_f32 v27, v27, s72, v24
    v_exp_f32 v26, v26
    v_exp_f32 v27, v27
    s_nop 0
    v_add_f32 v23, v23, v26
    v_cvt_pk_bf16_f32 v200, v26, v27
    v_add_f32 v23, v23, v27
    v_lshlrev_b32 v26, 16, v201
    v_and_b32 v27, 0xffff0000, v201
    v_fma_f32 v26, v26, s72, v24
    v_fma_f32 v27, v27, s72, v24
    v_exp_f32 v26, v26
    v_exp_f32 v27, v27
    s_nop 0
    v_add_f32 v23, v23, v26
    v_cvt_pk_bf16_f32 v201, v26, v27
    v_add_f32 v23, v23, v27
    v_lshlrev_b32 v26, 16, v202
    v_and_b32 v27, 0xffff0000, v202
    v_fma_f32 v26, v26, s72, v24
    v_fma_f32 v27, v27, s72, v24
    v_exp_f32 v26, v26
    v_exp_f32 v27, v27
    s_nop 0
    v_add_f32 v23, v23, v26
    v_cvt_pk_bf16_f32 v202, v26, v27
    v_add_f32 v23, v23, v27
    v_lshlrev_b32 v26, 16, v203
    v_and_b32 v27, 0xffff0000, v203
    v_fma_f32 v26, v26, s72, v24
    v_fma_f32 v27, v27, s72, v24
    v_exp_f32 v26, v26
    v_exp_f32 v27, v27
    s_nop 0
    v_add_f32 v23, v23, v26
    v_cvt_pk_bf16_f32 v203, v26, v27
    v_add_f32 v23, v23, v27
    s_waitcnt vmcnt(9)
    ds_read_b64_tr_b16 v[94:95], v14 offset:12288
    ds_read_b64_tr_b16 v[98:99], v15 offset:12288
    ds_read_b64_tr_b16 v[102:103], v16 offset:12288
    ds_read_b64_tr_b16 v[106:107], v17 offset:12288
    ds_read_b64_tr_b16 v[110:111], v18 offset:12288
    ds_read_b64_tr_b16 v[114:115], v19 offset:12288
    ds_read_b64_tr_b16 v[118:119], v20 offset:12288
    ds_read_b64_tr_b16 v[122:123], v21 offset:12288
    s_waitcnt lgkmcnt(8)
    s_add_u32 m0, s70, 8192
    s_nop 0
    buffer_load_dwordx4 v8, s[44:47], s81 offen offset:0 nt lds
    buffer_load_dwordx4 v9, s[44:47], s81 offen offset:1024 nt lds
    buffer_load_dwordx4 v8, s[44:47], s81 offen offset:2048 nt lds
    buffer_load_dwordx4 v9, s[44:47], s81 offen offset:3072 nt lds
    s_waitcnt lgkmcnt(0)
    s_add_u32 m0, s70, 12288
    s_nop 0
    buffer_load_dwordx4 v8, s[44:47], s69 offen offset:0 nt lds
    buffer_load_dwordx4 v9, s[44:47], s69 offen offset:1024 nt lds
    buffer_load_dwordx4 v8, s[44:47], s69 offen offset:2048 nt lds
    buffer_load_dwordx4 v9, s[44:47], s69 offen offset:3072 nt lds
    v_mfma_f32_16x16x32_bf16 v[124:127], v[92:95], v[200:203], v[124:127]
    v_mfma_f32_16x16x32_bf16 v[128:131], v[96:99], v[200:203], v[128:131]
    v_mfma_f32_16x16x32_bf16 v[132:135], v[100:103], v[200:203], v[132:135]
    v_mfma_f32_16x16x32_bf16 v[136:139], v[104:107], v[200:203], v[136:139]
    v_mfma_f32_16x16x32_bf16 v[140:143], v[108:111], v[200:203], v[140:143]
    v_mfma_f32_16x16x32_bf16 v[144:147], v[112:115], v[200:203], v[144:147]
    v_mfma_f32_16x16x32_bf16 v[148:151], v[116:119], v[200:203], v[148:151]
    v_mfma_f32_16x16x32_bf16 v[152:155], v[120:123], v[200:203], v[152:155]
    s_branch L_unit
L_lastunit:
    s_waitcnt lgkmcnt(0)
    v_mfma_f32_16x16x32_bf16 v[52:55], v[156:159], v[36:39], 0
    v_mfma_f32_16x16x32_bf16 v[52:55], v[160:163], v[40:43], v[52:55]
    v_mfma_f32_16x16x32_bf16 v[52:55], v[164:167], v[44:47], v[52:55]
    v_mfma_f32_16x16x32_bf16 v[52:55], v[168:171], v[48:51], v[52:55]
    s_waitcnt vmcnt(8)
    ds_read_b128 v[172:175], v10 offset:4096
    ds_read_b128 v[176:179], v11 offset:4096
    ds_read_b128 v[180:183], v12 offset:4096
    ds_read_b128 v[184:187], v13 offset:4096
    s_nop 3
    v_cvt_pk_bf16_f32 v26, v52, v53
    v_cvt_pk_bf16_f32 v27, v54, v55
    v_lshlrev_b32 v188, 16, v26
    v_and_b32 v189, 0xffff0000, v26
    v_lshlrev_b32 v190, 16, v27
    v_and_b32 v191, 0xffff0000, v27
    v_mul_f32 v188, s71, v188
    v_mul_f32 v189, s71, v189
    v_mul_f32 v190, s71, v190
    v_mul_f32 v191, s71, v191
    s_waitcnt lgkmcnt(0)
    v_mfma_f32_16x16x32_bf16 v[56:59], v[172:175], v[36:39], 0
    v_mfma_f32_16x16x32_bf16 v[56:59], v[176:179], v[40:43], v[56:59]
    v_mfma_f32_16x16x32_bf16 v[56:59], v[180:183], v[44:47], v[56:59]
    v_mfma_f32_16x16x32_bf16 v[56:59], v[184:187], v[48:51], v[56:59]
    v_cvt_pk_bf16_f32 v200, v188, v189
    v_cvt_pk_bf16_f32 v201, v190, v191
    v_max3_f32 v196, v188, v189, v190
    v_max_f32 v196, v196, v191
    s_nop 5
    v_cvt_pk_bf16_f32 v26, v56, v57
    v_cvt_pk_bf16_f32 v27, v58, v59
    v_lshlrev_b32 v192, 16, v26
    v_and_b32 v193, 0xffff0000, v26
    v_lshlrev_b32 v194, 16, v27
    v_and_b32 v195, 0xffff0000, v27
    v_mul_f32 v192, s71, v192
    v_mul_f32 v193, s71, v193
    v_mul_f32 v194, s71, v194
    v_mul_f32 v195, s71, v195
    v_cvt_pk_bf16_f32 v202, v192, v193
    v_cvt_pk_bf16_f32 v203, v194, v195
    v_max3_f32 v196, v196, v192, v193
    v_max3_f32 v196, v196, v194, v195
    v_mov_b32 v26, v196
    s_nop 1
    v_permlane32_swap_b32 v196, v26
    s_nop 1
    v_max_f32 v196, v196, v26
    v_mov_b32 v26, v196
    s_nop 1
    v_permlane16_swap_b32 v196, v26
    s_nop 1
    v_max_f32 v196, v196, v26
    v_cvt_pk_bf16_f32 v196, v196, v196
    v_and_b32 v196, 0xffff0000, v196
    v_cmp_gt_f32 vcc, v196, v22
    s_cbranch_vccz L_norescale_2
    v_max_f32 v196, v196, v22
    v_sub_f32 v26, v22, v196
    v_mul_f32 v26, s72, v26
    v_exp_f32 v26, v26
    v_mov_b32 v22, v196
    v_mul_f32 v24, s72, v22
    v_sub_f32 v24, 0, v24
    v_mul_f32 v23, v23, v26
    v_mul_f32 v124, v124, v26
    v_mul_f32 v125, v125, v26
    v_mul_f32 v126, v126, v26
    v_mul_f32 v127, v127, v26
    v_mul_f32 v128, v128, v26
    v_mul_f32 v129, v129, v26
    v_mul_f32 v130, v130, v26
    v_mul_f32 v131, v131, v26
    v_mul_f32 v132, v132, v26
    v_mul_f32 v133, v133, v26
    v_mul_f32 v134, v134, v26
    v_mul_f32 v135, v135, v26
    v_mul_f32 v136, v136, v26
    v_mul_f32 v137, v137, v26
    v_mul_f32 v138, v138, v26
    v_mul_f32 v139, v139, v26
    v_mul_f32 v140, v140, v26
    v_mul_f32 v141, v141, v26
    v_mul_f32 v142, v142, v26
    v_mul_f32 v143, v143, v26
    v_mul_f32 v144, v144, v26
    v_mul_f32 v145, v145, v26
    v_mul_f32 v146, v146, v26
    v_mul_f32 v147, v147, v26
    v_mul_f32 v148, v148, v26
    v_mul_f32 v149, v149, v26
    v_mul_f32 v150, v150, v26
    v_mul_f32 v151, v151, v26
    v_mul_f32 v152, v152, v26
    v_mul_f32 v153, v153, v26
    v_mul_f32 v154, v154, v26
    v_mul_f32 v155, v155, v26
L_norescale_2:
    s_waitcnt vmcnt(4)
    ds_read_b64_tr_b16 v[92:93], v14 offset:8192
    ds_read_b64_tr_b16 v[96:97], v15 offset:8192
    ds_read_b64_tr_b16 v[100:101], v16 offset:8192
    ds_read_b64_tr_b16 v[104:105], v17 offset:8192
    ds_read_b64_tr_b16 v[108:109], v18 offset:8192
    ds_read_b64_tr_b16 v[112:113], v19 offset:8192
    ds_read_b64_tr_b16 v[116:117], v20 offset:8192
    ds_read_b64_tr_b16 v[120:121], v21 offset:8192
    v_lshlrev_b32 v26, 16, v200
    v_and_b32 v27, 0xffff0000, v200
    v_fma_f32 v26, v26, s72, v24
    v_fma_f32 v27, v27, s72, v24
    v_exp_f32 v26, v26
    v_exp_f32 v27, v27
    s_nop 0
    v_add_f32 v23, v23, v26
    v_cvt_pk_bf16_f32 v200, v26, v27
    v_add_f32 v23, v23, v27
    v_lshlrev_b32 v26, 16, v201
    v_and_b32 v27, 0xffff0000, v201
    v_fma_f32 v26, v26, s72, v24
    v_fma_f32 v27, v27, s72, v24
    v_exp_f32 v26, v26
    v_exp_f32 v27, v27
    s_nop 0
    v_add_f32 v23, v23, v26
    v_cvt_pk_bf16_f32 v201, v26, v27
    v_add_f32 v23, v23, v27
    v_lshlrev_b32 v26, 16, v202
    v_and_b32 v27, 0xffff0000, v202
    v_fma_f32 v26, v26, s72, v24
    v_fma_f32 v27, v27, s72, v24
    v_exp_f32 v26, v26
    v_exp_f32 v27, v27
    s_nop 0
    v_add_f32 v23, v23, v26
    v_cvt_pk_bf16_f32 v202, v26, v27
    v_add_f32 v23, v23, v27
    v_lshlrev_b32 v26, 16, v203
    v_and_b32 v27, 0xffff0000, v203
    v_fma_f32 v26, v26, s72, v24
    v_fma_f32 v27, v27, s72, v24
    v_exp_f32 v26, v26
    v_exp_f32 v27, v27
    s_nop 0
    v_add_f32 v23, v23, v26
    v_cvt_pk_bf16_f32 v203, v26, v27
    v_add_f32 v23, v23, v27
    s_waitcnt vmcnt(0)
    ds_read_b64_tr_b16 v[94:95], v14 offset:12288
    ds_read_b64_tr_b16 v[98:99], v15 offset:12288
    ds_read_b64_tr_b16 v[102:103], v16 offset:12288
    ds_read_b64_tr_b16 v[106:107], v17 offset:12288
    ds_read_b64_tr_b16 v[110:111], v18 offset:12288
    ds_read_b64_tr_b16 v[114:115], v19 offset:12288
    ds_read_b64_tr_b16 v[118:119], v20 offset:12288
    ds_read_b64_tr_b16 v[122:123], v21 offset:12288
    s_waitcnt lgkmcnt(0)
    v_mfma_f32_16x16x32_bf16 v[124:127], v[92:95], v[200:203], v[124:127]
    v_mfma_f32_16x16x32_bf16 v[128:131], v[96:99], v[200:203], v[128:131]
    v_mfma_f32_16x16x32_bf16 v[132:135], v[100:103], v[200:203], v[132:135]
    v_mfma_f32_16x16x32_bf16 v[136:139], v[104:107], v[200:203], v[136:139]
    v_mfma_f32_16x16x32_bf16 v[140:143], v[108:111], v[200:203], v[140:143]
    v_mfma_f32_16x16x32_bf16 v[144:147], v[112:115], v[200:203], v[144:147]
    v_mfma_f32_16x16x32_bf16 v[148:151], v[116:119], v[200:203], v[148:151]
    v_mfma_f32_16x16x32_bf16 v[152:155], v[120:123], v[200:203], v[152:155]
    v_lshlrev_b32 v26, 9, v1
    v_lshl_or_b32 v26, v2, 4, v26
    v_add_u32 v26, s70, v26
    v_lshlrev_b32 v27, 5, v1
    v_lshl_or_b32 v27, v2, 3, v27
    v_add_u32 v27, s70, v27
    s_mov_b32 exec_lo, 0x000f000f
    s_mov_b32 exec_hi, 0x000f000f
    ds_write_b64 v27, v[22:23] offset:2048
    s_nop 1
    ds_write_b128 v26, v[124:127] offset:0
    ds_write_b128 v26, v[128:131] offset:64
    ds_write_b128 v26, v[132:135] offset:128
    ds_write_b128 v26, v[136:139] offset:192
    ds_write_b128 v26, v[140:143] offset:256
    ds_write_b128 v26, v[144:147] offset:320
    ds_write_b128 v26, v[148:151] offset:384
    ds_write_b128 v26, v[152:155] offset:448
    s_waitcnt lgkmcnt(0)
    s_barrier
    s_waitcnt vmcnt(0)
    s_endpgm
L_helper:
    s_setprio 3
    s_sub_u32 s70, s68, 4
    s_lshl_b32 s69, s70, 14
    s_add_u32 s69, s69, 76288
    v_lshlrev_b32 v3, 4, v0
    v_mov_b32 v60, -1
    v_mov_b32 v61, -1
    v_mov_b32 v62, -1
    v_mov_b32 v63, -1
    s_waitcnt lgkmcnt(0)
    s_mov_b32 s48, s38
    s_and_b32 s49, s39, 0xffff
    s_mov_b32 s50, 0x20000000
    s_mov_b32 s51, 0x00020000
    s_mov_b32 s52, s36
    s_and_b32 s53, s37, 0xffff
    s_mov_b32 s54, 0x100
    s_mov_b32 s55, 0x00020000
    s_mov_b32 s60, s16
    s_and_b32 s61, s17, 0xffff
    s_mov_b32 s62, 0x1000
    s_mov_b32 s63, 0x00020000
    s_mov_b32 s100, s74
    s_mov_b32 s101, s74
    s_cmp_lg_u32 s70, 0
    s_cbranch_scc1 L_not0
    v_lshlrev_b32 v4, 4, v1
    v_lshl_or_b32 v4, v2, 10, v4
    s_add_u32 s78, s75, 0
    s_and_b32 s78, s78, 3
    s_lshl_b32 s78, s78, 8
    buffer_load_dwordx4 v[8:11], v4, s[60:63], s78 offen
    s_add_u32 s79, s75, 1
    s_and_b32 s79, s79, 3
    s_lshl_b32 s79, s79, 8
    buffer_load_dwordx4 v[12:15], v4, s[60:63], s79 offen
    s_add_u32 s80, s75, 2
    s_and_b32 s80, s80, 3
    s_lshl_b32 s80, s80, 8
    buffer_load_dwordx4 v[16:19], v4, s[60:63], s80 offen
    s_add_u32 s81, s75, 3
    s_and_b32 s81, s81, 3
    s_lshl_b32 s81, s81, 8
    buffer_load_dwordx4 v[20:23], v4, s[60:63], s81 offen
    s_mov_b32 s56, s22
    s_and_b32 s57, s23, 0xffff
    s_mov_b32 s58, 0x400000
    s_mov_b32 s59, 0x00020000
    v_lshrrev_b32 v4, 3, v0
    v_and_b32 v5, 7, v0
    v_lshlrev_b32 v5, 4, v5
    v_lshl_or_b32 v6, v4, 13, v5
    s_lshl_b32 s80, s75, 20
    s_lshl_b32 s81, s73, 10
    s_add_u32 s80, s80, s81
    s_lshl_b32 s81, s100, 7
    s_add_u32 s80, s80, s81
    s_add_u32 m0, s69, 0
    s_mov_b32 s93, s80
    buffer_load_dwordx4 v6, s[56:59], s93 offen nt lds
    s_add_u32 m0, s69, 1024
    s_add_u32 s93, s93, 65536
    buffer_load_dwordx4 v6, s[56:59], s93 offen nt lds
    s_add_u32 m0, s69, 2048
    s_add_u32 s93, s93, 65536
    buffer_load_dwordx4 v6, s[56:59], s93 offen nt lds
    s_add_u32 m0, s69, 3072
    s_add_u32 s93, s93, 65536
    buffer_load_dwordx4 v6, s[56:59], s93 offen nt lds
    s_add_u32 m0, s69, 4096
    s_add_u32 s93, s93, 65536
    buffer_load_dwordx4 v6, s[56:59], s93 offen nt lds
    s_add_u32 m0, s69, 5120
    s_add_u32 s93, s93, 65536
    buffer_load_dwordx4 v6, s[56:59], s93 offen nt lds
    s_add_u32 m0, s69, 6144
    s_add_u32 s93, s93, 65536
    buffer_load_dwordx4 v6, s[56:59], s93 offen nt lds
    s_add_u32 m0, s69, 7168
    s_add_u32 s93, s93, 65536
    buffer_load_dwordx4 v6, s[56:59], s93 offen nt lds
    s_add_u32 m0, s69, 8192
    s_add_u32 s93, s93, 65536
    buffer_load_dwordx4 v6, s[56:59], s93 offen nt lds
    s_add_u32 m0, s69, 9216
    s_add_u32 s93, s93, 65536
    buffer_load_dwordx4 v6, s[56:59], s93 offen nt lds
    s_add_u32 m0, s69, 10240
    s_add_u32 s93, s93, 65536
    buffer_load_dwordx4 v6, s[56:59], s93 offen nt lds
    s_add_u32 m0, s69, 11264
    s_add_u32 s93, s93, 65536
    buffer_load_dwordx4 v6, s[56:59], s93 offen nt lds
    s_add_u32 m0, s69, 12288
    s_add_u32 s93, s93, 65536
    buffer_load_dwordx4 v6, s[56:59], s93 offen nt lds
    s_add_u32 m0, s69, 13312
    s_add_u32 s93, s93, 65536
    buffer_load_dwordx4 v6, s[56:59], s93 offen nt lds
    s_add_u32 m0, s69, 14336
    s_add_u32 s93, s93, 65536
    buffer_load_dwordx4 v6, s[56:59], s93 offen nt lds
    s_add_u32 m0, s69, 15360
    s_add_u32 s93, s93, 65536
    buffer_load_dwordx4 v6, s[56:59], s93 offen nt lds
    s_barrier
    v_lshlrev_b32 v57, 16, v1
    v_lshl_or_b32 v57, v2, 4, v57
    s_lshl_b32 s90, s73, 13
    s_lshl_b32 s81, s75, 11
    s_add_u32 s90, s90, s81
    s_lshl_b32 s81, s100, 8
    s_add_u32 s90, s90, s81
    s_add_u32 s90, s90, 1703936
    s_lshl_b32 s91, s73, 4
    s_and_b32 s93, s73, 4
    s_lshl_b32 s93, s93, 5
    s_add_u32 s91, s91, s93
    v_lshrrev_b32 v58, 2, v1
    v_lshl_add_u32 v58, v2, 3, v58
    v_and_b32 v59, 3, v1
    v_lshlrev_b32 v59, 3, v59
    v_lshl_or_b32 v58, v58, 7, v59
    v_add_u32 v58, s69, v58
    v_and_b32 v56, 3, v1
    v_lshlrev_b32 v56, 8, v56
    v_lshl_or_b32 v56, v2, 4, v56
    v_mov_b32 v55, 0
    s_waitcnt vmcnt(16)
    v_lshlrev_b32 v64, 16, v8
    v_and_b32 v65, 0xffff0000, v8
    v_lshlrev_b32 v66, 16, v9
    v_and_b32 v67, 0xffff0000, v9
    v_lshlrev_b32 v68, 16, v10
    v_and_b32 v69, 0xffff0000, v10
    v_lshlrev_b32 v70, 16, v11
    v_and_b32 v71, 0xffff0000, v11
    v_lshlrev_b32 v72, 16, v12
    v_and_b32 v73, 0xffff0000, v12
    v_lshlrev_b32 v74, 16, v13
    v_and_b32 v75, 0xffff0000, v13
    v_lshlrev_b32 v76, 16, v14
    v_and_b32 v77, 0xffff0000, v14
    v_lshlrev_b32 v78, 16, v15
    v_and_b32 v79, 0xffff0000, v15
    v_lshlrev_b32 v80, 16, v16
    v_and_b32 v81, 0xffff0000, v16
    v_lshlrev_b32 v82, 16, v17
    v_and_b32 v83, 0xffff0000, v17
    v_lshlrev_b32 v84, 16, v18
    v_and_b32 v85, 0xffff0000, v18
    v_lshlrev_b32 v86, 16, v19
    v_and_b32 v87, 0xffff0000, v19
    v_lshlrev_b32 v88, 16, v20
    v_and_b32 v89, 0xffff0000, v20
    v_lshlrev_b32 v90, 16, v21
    v_and_b32 v91, 0xffff0000, v21
    v_lshlrev_b32 v92, 16, v22
    v_and_b32 v93, 0xffff0000, v22
    v_lshlrev_b32 v94, 16, v23
    v_and_b32 v95, 0xffff0000, v23
    v_pk_add_f32 v[4:5], v[64:65], v[66:67]
    v_pk_add_f32 v[6:7], v[68:69], v[70:71]
    v_pk_add_f32 v[4:5], v[4:5], v[72:73]
    v_pk_add_f32 v[6:7], v[6:7], v[74:75]
    v_pk_add_f32 v[4:5], v[4:5], v[76:77]
    v_pk_add_f32 v[6:7], v[6:7], v[78:79]
    v_pk_add_f32 v[4:5], v[4:5], v[80:81]
    v_pk_add_f32 v[6:7], v[6:7], v[82:83]
    v_pk_add_f32 v[4:5], v[4:5], v[84:85]
    v_pk_add_f32 v[6:7], v[6:7], v[86:87]
    v_pk_add_f32 v[4:5], v[4:5], v[88:89]
    v_pk_add_f32 v[6:7], v[6:7], v[90:91]
    v_pk_add_f32 v[4:5], v[4:5], v[92:93]
    v_pk_add_f32 v[6:7], v[6:7], v[94:95]
    v_pk_add_f32 v[4:5], v[4:5], v[6:7]
    v_add_f32 v4, v4, v5
    s_nop 1
    v_add_f32_dpp v4, v4, v4 row_ror:8 row_mask:0xf bank_mask:0xf
    s_nop 1
    v_add_f32_dpp v4, v4, v4 row_ror:4 row_mask:0xf bank_mask:0xf
    s_nop 1
    v_add_f32_dpp v4, v4, v4 row_ror:2 row_mask:0xf bank_mask:0xf
    s_nop 1
    v_add_f32_dpp v4, v4, v4 row_ror:1 row_mask:0xf bank_mask:0xf
    v_mul_f32 v24, 0xbb000000, v4
    v_mul_f32 v25, 0xbb000000, v4
    v_pk_add_f32 v[26:27], v[64:65], v[24:25]
    v_pk_mul_f32 v[4:5], v[26:27], v[26:27]
    v_pk_add_f32 v[28:29], v[66:67], v[24:25]
    v_pk_mul_f32 v[6:7], v[28:29], v[28:29]
    v_pk_add_f32 v[26:27], v[68:69], v[24:25]
    v_pk_fma_f32 v[4:5], v[26:27], v[26:27], v[4:5]
    v_pk_add_f32 v[28:29], v[70:71], v[24:25]
    v_pk_fma_f32 v[6:7], v[28:29], v[28:29], v[6:7]
    v_pk_add_f32 v[26:27], v[72:73], v[24:25]
    v_pk_fma_f32 v[4:5], v[26:27], v[26:27], v[4:5]
    v_pk_add_f32 v[28:29], v[74:75], v[24:25]
    v_pk_fma_f32 v[6:7], v[28:29], v[28:29], v[6:7]
    v_pk_add_f32 v[26:27], v[76:77], v[24:25]
    v_pk_fma_f32 v[4:5], v[26:27], v[26:27], v[4:5]
    v_pk_add_f32 v[28:29], v[78:79], v[24:25]
    v_pk_fma_f32 v[6:7], v[28:29], v[28:29], v[6:7]
    v_pk_add_f32 v[26:27], v[80:81], v[24:25]
    v_pk_fma_f32 v[4:5], v[26:27], v[26:27], v[4:5]
    v_pk_add_f32 v[28:29], v[82:83], v[24:25]
    v_pk_fma_f32 v[6:7], v[28:29], v[28:29], v[6:7]
    v_pk_add_f32 v[26:27], v[84:85], v[24:25]
    v_pk_fma_f32 v[4:5], v[26:27], v[26:27], v[4:5]
    v_pk_add_f32 v[28:29], v[86:87], v[24:25]
    v_pk_fma_f32 v[6:7], v[28:29], v[28:29], v[6:7]
    v_pk_add_f32 v[26:27], v[88:89], v[24:25]
    v_pk_fma_f32 v[4:5], v[26:27], v[26:27], v[4:5]
    v_pk_add_f32 v[28:29], v[90:91], v[24:25]
    v_pk_fma_f32 v[6:7], v[28:29], v[28:29], v[6:7]
    v_pk_add_f32 v[26:27], v[92:93], v[24:25]
    v_pk_fma_f32 v[4:5], v[26:27], v[26:27], v[4:5]
    v_pk_add_f32 v[28:29], v[94:95], v[24:25]
    v_pk_fma_f32 v[6:7], v[28:29], v[28:29], v[6:7]
    v_pk_add_f32 v[4:5], v[4:5], v[6:7]
    v_add_f32 v4, v4, v5
    s_nop 1
    v_add_f32_dpp v4, v4, v4 row_ror:8 row_mask:0xf bank_mask:0xf
    s_nop 1
    v_add_f32_dpp v4, v4, v4 row_ror:4 row_mask:0xf bank_mask:0xf
    s_nop 1
    v_add_f32_dpp v4, v4, v4 row_ror:2 row_mask:0xf bank_mask:0xf
    s_nop 1
    v_add_f32_dpp v4, v4, v4 row_ror:1 row_mask:0xf bank_mask:0xf
    v_mul_f32 v30, 0x3b000000, v4
    v_cvt_pk_bf16_f32 v30, v30, v30
    v_and_b32 v30, 0xffff0000, v30
    v_add_f32 v30, 0x3727c5ac, v30
    v_cvt_pk_bf16_f32 v30, v30, v30
    v_and_b32 v30, 0xffff0000, v30
    v_sqrt_f32 v30, v30
    v_cvt_pk_bf16_f32 v24, v24, v24
    v_and_b32 v24, 0xffff0000, v24
    v_cvt_pk_bf16_f32 v30, v30, v30
    v_and_b32 v30, 0xffff0000, v30
    v_rcp_f32 v30, v30
    v_mov_b32 v25, v24
    v_pk_add_f32 v[64:65], v[64:65], v[24:25]
    v_pk_add_f32 v[66:67], v[66:67], v[24:25]
    v_pk_add_f32 v[68:69], v[68:69], v[24:25]
    v_pk_add_f32 v[70:71], v[70:71], v[24:25]
    v_cvt_pk_bf16_f32 v26, v64, v65
    v_cvt_pk_bf16_f32 v27, v66, v67
    v_cvt_pk_bf16_f32 v28, v68, v69
    v_cvt_pk_bf16_f32 v29, v70, v71
    v_lshlrev_b32 v64, 16, v26
    v_and_b32 v65, 0xffff0000, v26
    v_mul_f32 v64, v64, v30
    v_mul_f32 v65, v65, v30
    v_lshlrev_b32 v66, 16, v27
    v_and_b32 v67, 0xffff0000, v27
    v_mul_f32 v66, v66, v30
    v_mul_f32 v67, v67, v30
    v_lshlrev_b32 v68, 16, v28
    v_and_b32 v69, 0xffff0000, v28
    v_mul_f32 v68, v68, v30
    v_mul_f32 v69, v69, v30
    v_lshlrev_b32 v70, 16, v29
    v_and_b32 v71, 0xffff0000, v29
    v_mul_f32 v70, v70, v30
    v_mul_f32 v71, v71, v30
    v_cvt_pk_bf16_f32 v20, v64, v65
    v_cvt_pk_bf16_f32 v21, v66, v67
    v_cvt_pk_bf16_f32 v22, v68, v69
    v_cvt_pk_bf16_f32 v23, v70, v71
    ds_write_b128 v3, v[20:23] offset:0
    s_waitcnt lgkmcnt(0)
    ds_read_b128 v[96:99], v56 offset:0
    ds_read_b128 v[100:103], v56 offset:64
    ds_read_b128 v[104:107], v56 offset:128
    ds_read_b128 v[108:111], v56 offset:192
    s_waitcnt vmcnt(0)
    buffer_load_dwordx4 v[36:39], v55, s[52:55], s91 offen sc1
    ds_read_b64_tr_b16 v[128:129], v58 offset:0
    ds_read_b64_tr_b16 v[130:131], v58 offset:512
    ds_read_b64_tr_b16 v[132:133], v58 offset:32
    ds_read_b64_tr_b16 v[134:135], v58 offset:544
    ds_read_b64_tr_b16 v[136:137], v58 offset:64
    ds_read_b64_tr_b16 v[138:139], v58 offset:576
    ds_read_b64_tr_b16 v[140:141], v58 offset:96
    ds_read_b64_tr_b16 v[142:143], v58 offset:608
    ds_read_b64_tr_b16 v[144:145], v58 offset:4096
    ds_read_b64_tr_b16 v[146:147], v58 offset:4608
    ds_read_b64_tr_b16 v[148:149], v58 offset:4128
    ds_read_b64_tr_b16 v[150:151], v58 offset:4640
    ds_read_b64_tr_b16 v[152:153], v58 offset:4160
    ds_read_b64_tr_b16 v[154:155], v58 offset:4672
    ds_read_b64_tr_b16 v[156:157], v58 offset:4192
    ds_read_b64_tr_b16 v[158:159], v58 offset:4704
    ds_read_b64_tr_b16 v[160:161], v58 offset:8192
    ds_read_b64_tr_b16 v[162:163], v58 offset:8704
    ds_read_b64_tr_b16 v[164:165], v58 offset:8224
    ds_read_b64_tr_b16 v[166:167], v58 offset:8736
    ds_read_b64_tr_b16 v[168:169], v58 offset:8256
    ds_read_b64_tr_b16 v[170:171], v58 offset:8768
    ds_read_b64_tr_b16 v[172:173], v58 offset:8288
    ds_read_b64_tr_b16 v[174:175], v58 offset:8800
    ds_read_b64_tr_b16 v[176:177], v58 offset:12288
    ds_read_b64_tr_b16 v[178:179], v58 offset:12800
    ds_read_b64_tr_b16 v[180:181], v58 offset:12320
    ds_read_b64_tr_b16 v[182:183], v58 offset:12832
    ds_read_b64_tr_b16 v[184:185], v58 offset:12352
    ds_read_b64_tr_b16 v[186:187], v58 offset:12864
    ds_read_b64_tr_b16 v[188:189], v58 offset:12384
    ds_read_b64_tr_b16 v[190:191], v58 offset:12896
    s_waitcnt lgkmcnt(15)
    v_mfma_f32_16x16x32_bf16 v[8:11], v[128:131], v[96:99], 0
    s_waitcnt lgkmcnt(15)
    v_mfma_f32_16x16x32_bf16 v[12:15], v[132:135], v[96:99], 0
    s_waitcnt lgkmcnt(15)
    v_mfma_f32_16x16x32_bf16 v[16:19], v[136:139], v[96:99], 0
    s_waitcnt lgkmcnt(15)
    v_mfma_f32_16x16x32_bf16 v[20:23], v[140:143], v[96:99], 0
    s_waitcnt lgkmcnt(15)
    v_mfma_f32_16x16x32_bf16 v[8:11], v[144:147], v[100:103], v[8:11]
    s_waitcnt lgkmcnt(15)
    v_mfma_f32_16x16x32_bf16 v[12:15], v[148:151], v[100:103], v[12:15]
    s_waitcnt lgkmcnt(15)
    v_mfma_f32_16x16x32_bf16 v[16:19], v[152:155], v[100:103], v[16:19]
    s_waitcnt lgkmcnt(15)
    v_mfma_f32_16x16x32_bf16 v[20:23], v[156:159], v[100:103], v[20:23]
    s_waitcnt lgkmcnt(14)
    v_mfma_f32_16x16x32_bf16 v[8:11], v[160:163], v[104:107], v[8:11]
    s_waitcnt lgkmcnt(12)
    v_mfma_f32_16x16x32_bf16 v[12:15], v[164:167], v[104:107], v[12:15]
    s_waitcnt lgkmcnt(10)
    v_mfma_f32_16x16x32_bf16 v[16:19], v[168:171], v[104:107], v[16:19]
    s_waitcnt lgkmcnt(8)
    v_mfma_f32_16x16x32_bf16 v[20:23], v[172:175], v[104:107], v[20:23]
    s_waitcnt lgkmcnt(6)
    v_mfma_f32_16x16x32_bf16 v[8:11], v[176:179], v[108:111], v[8:11]
    s_waitcnt lgkmcnt(4)
    v_mfma_f32_16x16x32_bf16 v[12:15], v[180:183], v[108:111], v[12:15]
    s_waitcnt lgkmcnt(2)
    v_mfma_f32_16x16x32_bf16 v[16:19], v[184:187], v[108:111], v[16:19]
    s_waitcnt lgkmcnt(0)
    v_mfma_f32_16x16x32_bf16 v[20:23], v[188:191], v[108:111], v[20:23]
    s_nop 7
    v_and_b32 v8, -2, v8
    v_and_b32 v9, -2, v9
    v_and_b32 v10, -2, v10
    v_and_b32 v11, -2, v11
    v_and_b32 v12, -2, v12
    v_and_b32 v13, -2, v13
    v_and_b32 v14, -2, v14
    v_and_b32 v15, -2, v15
    v_and_b32 v16, -2, v16
    v_and_b32 v17, -2, v17
    v_and_b32 v18, -2, v18
    v_and_b32 v19, -2, v19
    v_and_b32 v20, -2, v20
    v_and_b32 v21, -2, v21
    v_and_b32 v22, -2, v22
    v_and_b32 v23, -2, v23
    s_waitcnt vmcnt(0)
    v_and_b32 v36, v36, v37
    v_and_b32 v38, v38, v39
    v_and_b32 v36, v36, v38
    v_cmp_ne_u32 vcc, 1, v36
    s_nop 1
    s_cbranch_vccz L_qfok
    s_mov_b32 s96, 100000
L_qf_3:
    buffer_load_dwordx4 v[32:35], v55, s[52:55], s91 offen sc1
    s_waitcnt vmcnt(0)
    v_and_b32 v252, v32, v33
    v_and_b32 v252, v252, v34
    v_and_b32 v252, v252, v35
    v_cmp_ne_u32 vcc, 0x1, v252
    s_cbranch_vccz L_qfd_4
    s_sub_u32 s96, s96, 1
    s_cmp_eq_u32 s96, 0
    s_cbranch_scc1 L_qfd_4
    s_sleep 1
    s_branch L_qf_3
L_qfd_4:
L_qfok:
    s_mov_b32 s96, 800000
L_cf:
    ds_read_b32 v54, v55 offset:10312
    s_waitcnt lgkmcnt(0)
    v_cmp_ne_u32 vcc, 1, v54
    s_cbranch_vccz L_cfd
    s_sub_u32 s96, s96, 1
    s_cmp_eq_u32 s96, 0
    s_cbranch_scc1 L_cfd
    s_sleep 1
    s_branch L_cf
L_cfd:
    s_mov_b32 exec_lo, 0x000f000f
    s_mov_b32 exec_hi, 0x000f000f
    buffer_store_dwordx4 v[8:11], v57, s[48:51], s90 offen offset:0 sc1
    buffer_store_dwordx4 v[12:15], v57, s[48:51], s90 offen offset:64 sc1
    buffer_store_dwordx4 v[16:19], v57, s[48:51], s90 offen offset:128 sc1
    buffer_store_dwordx4 v[20:23], v57, s[48:51], s90 offen offset:192 sc1
    s_mov_b64 exec, -1
    v_mov_b32 v54, 1
    ds_write_b32 v55, v54 offset:10304
    s_branch L_qpoll
L_not0:
    v_mov_b32 v55, 0
    s_cmp_lg_u32 s70, 1
    s_cbranch_scc1 L_not1
    ds_write_b32 v55, v55 offset:10304
    ds_write_b32 v55, v55 offset:10308
    ds_write_b32 v55, v55 offset:10312
    ds_write_b32 v55, v55 offset:10316
    ds_write_b32 v55, v55 offset:10320
    ds_write_b32 v55, v55 offset:10324
    s_cmp_lg_u32 s74, 0
    s_cbranch_scc1 L_not1
    s_lshl_b32 s80, s76, 13
    s_add_u32 s80, s80, 1703936
    s_add_u32 s81, s80, 4096
    buffer_store_dwordx4 v[60:63], v3, s[48:51], s80 offen offset:0 sc1
    buffer_store_dwordx4 v[60:63], v3, s[48:51], s80 offen offset:1024 sc1
    buffer_store_dwordx4 v[60:63], v3, s[48:51], s80 offen offset:2048 sc1
    buffer_store_dwordx4 v[60:63], v3, s[48:51], s80 offen offset:3072 sc1
    buffer_store_dwordx4 v[60:63], v3, s[48:51], s81 offen offset:0 sc1
    buffer_store_dwordx4 v[60:63], v3, s[48:51], s81 offen offset:1024 sc1
    buffer_store_dwordx4 v[60:63], v3, s[48:51], s81 offen offset:2048 sc1
    buffer_store_dwordx4 v[60:63], v3, s[48:51], s81 offen offset:3072 sc1
    s_lshl_b32 s78, s76, 8
    s_add_u32 s78, s78, 32768
    s_mov_b64 exec, 1
    buffer_store_dword v55, v55, s[48:51], s78 offen sc1
    s_mov_b64 exec, -1
    s_waitcnt lgkmcnt(0)
    s_barrier
    s_lshl_b32 s91, s73, 4
    s_and_b32 s93, s73, 4
    s_lshl_b32 s93, s93, 5
    s_add_u32 s91, s91, s93
    s_lshl_b32 s90, s75, 2
    s_add_u32 s91, s91, s90
    v_mov_b32 v4, 1
    s_waitcnt vmcnt(0)
    s_mov_b64 exec, 1
    buffer_store_dword v4, v55, s[52:55], s91 offen sc1
    s_mov_b64 exec, -1
    s_branch L_ldsflag
L_not1:
    s_cmp_lg_u32 s70, 2
    s_cbranch_scc1 L_not2
    s_lshl_b32 s78, s76, 3
    s_add_u32 s78, s78, s74
    s_mul_i32 s79, s78, 3072
    s_add_u32 s79, s79, 65536
    buffer_store_dwordx4 v[60:63], v3, s[48:51], s79 offen offset:0 sc1
    buffer_store_dwordx4 v[60:63], v3, s[48:51], s79 offen offset:1024 sc1
    buffer_store_dwordx4 v[60:63], v3, s[48:51], s79 offen offset:2048 sc1
    s_lshl_b32 s79, s78, 8
    s_add_u32 s79, s79, 1048576
    v_lshlrev_b32 v4, 4, v1
    buffer_store_dwordx4 v[60:63], v4, s[48:51], s79 offen sc1
    s_cmp_ge_u32 s77, 56
    s_cbranch_scc1 L_nod3
    s_and_b32 s79, s75, 2
    s_mul_i32 s79, s79, 56
    s_add_u32 s79, s79, s77
    s_lshl_b32 s79, s79, 11
    s_add_u32 s79, s79, 1114112
    s_add_u32 s80, s79, 114688
    buffer_store_dwordx4 v[60:63], v3, s[48:51], s79 offen offset:0 sc1
    buffer_store_dwordx4 v[60:63], v3, s[48:51], s79 offen offset:1024 sc1
    buffer_store_dwordx4 v[60:63], v3, s[48:51], s80 offen offset:0 sc1
    buffer_store_dwordx4 v[60:63], v3, s[48:51], s80 offen offset:1024 sc1
L_nod3:
    s_barrier
    v_mov_b32 v4, 1
    s_waitcnt vmcnt(0)
    ds_write_b32 v55, v4 offset:10312
    s_branch L_ldsflag
L_not2:
    s_waitcnt lgkmcnt(0)
    s_barrier
L_ldsflag:
    s_mov_b32 s96, 800000
L_lf:
    ds_read_b32 v4, v55 offset:10304
    s_waitcnt lgkmcnt(0)
    v_cmp_ne_u32 vcc, 1, v4
    s_cbranch_vccz L_qpoll
    s_sub_u32 s96, s96, 1
    s_cmp_eq_u32 s96, 0
    s_cbranch_scc1 L_qpoll
    s_sleep 1
    s_branch L_lf
L_qpoll:
    s_lshl_b32 s78, s76, 13
    s_lshl_b32 s79, s70, 9
    s_add_u32 s78, s78, s79
    s_add_u32 s78, s78, 1703936
    s_add_u32 s80, s78, 4096
    v_lshlrev_b32 v4, 3, v0
    s_mov_b32 s96, 100000
L_q_5:
    buffer_load_dwordx2 v[8:9], v4, s[48:51], s78 offen offset:0 sc1
    buffer_load_dwordx2 v[10:11], v4, s[48:51], s78 offen offset:2048 sc1
    buffer_load_dwordx2 v[12:13], v4, s[48:51], s80 offen offset:0 sc1
    buffer_load_dwordx2 v[14:15], v4, s[48:51], s80 offen offset:2048 sc1
    s_waitcnt vmcnt(0)
    v_max_u32 v252, v8, v9
    v_max3_u32 v252, v252, v10, v11
    v_max3_u32 v252, v252, v12, v13
    v_max3_u32 v252, v252, v14, v15
    v_cmp_eq_u32 vcc, -1, v252
    s_cbranch_vccz L_qd_6
    s_sub_u32 s96, s96, 1
    s_cmp_eq_u32 s96, 0
    s_cbranch_scc1 L_qd_6
    s_sleep 2
    s_branch L_q_5
L_qd_6:
    v_pk_add_f32 v[8:9], v[8:9], v[10:11]
    v_pk_add_f32 v[12:13], v[12:13], v[14:15]
    v_pk_add_f32 v[8:9], v[8:9], v[12:13]
    s_lshr_b32 s79, s79, 1
    v_lshrrev_b32 v4, 1, v4
    v_add_u32 v4, s79, v4
    v_cvt_pk_bf16_f32 v8, v8, v9
    ds_write_b32 v4, v8 offset:4096
    s_waitcnt lgkmcnt(0)
L_joinB:
    s_barrier
    s_add_u32 s78, s75, s74
    s_add_u32 s78, s78, s70
    s_cmp_lg_u32 s78, 0
    s_cbranch_scc1 L_norep
    s_lshl_b32 s79, s73, 2
    v_mov_b32 v4, 1
    v_mov_b32 v5, 0
    s_mov_b64 exec, 1
    buffer_store_dword v4, v5, s[52:55], s79 offen offset:128 sc1
    s_mov_b64 exec, -1
L_norep:
    s_waitcnt vmcnt(0)
    v_mov_b32 v64, -1
    v_mov_b32 v65, -1
    v_mov_b32 v66, -1
    v_mov_b32 v67, -1
    v_mov_b32 v68, -1
    v_mov_b32 v69, -1
    v_mov_b32 v70, -1
    v_mov_b32 v71, -1
    v_mov_b32 v72, -1
    v_mov_b32 v73, -1
    v_mov_b32 v74, -1
    v_mov_b32 v75, -1
    v_mov_b32 v76, -1
    v_mov_b32 v77, -1
    v_mov_b32 v78, -1
    v_mov_b32 v79, -1
    v_mov_b32 v80, -1
    v_mov_b32 v81, -1
    v_mov_b32 v82, -1
    v_mov_b32 v83, -1
    v_mov_b32 v84, -1
    v_mov_b32 v85, -1
    v_mov_b32 v86, -1
    v_mov_b32 v87, -1
    v_mov_b32 v88, -1
    v_mov_b32 v89, -1
    v_mov_b32 v90, -1
    v_mov_b32 v91, -1
    v_mov_b32 v92, -1
    v_mov_b32 v93, -1
    v_mov_b32 v94, -1
    v_mov_b32 v95, -1
    v_mov_b32 v96, -1
    v_mov_b32 v97, -1
    v_mov_b32 v98, -1
    v_mov_b32 v99, -1
    v_mov_b32 v100, -1
    v_mov_b32 v101, -1
    v_mov_b32 v102, -1
    v_mov_b32 v103, -1
    v_mov_b32 v128, -1
    v_mov_b32 v129, -1
    v_mov_b32 v130, -1
    v_mov_b32 v131, -1
    v_mov_b32 v132, -1
    v_mov_b32 v133, -1
    v_mov_b32 v134, -1
    v_mov_b32 v135, -1
    v_mov_b32 v136, -1
    v_mov_b32 v137, -1
    v_mov_b32 v138, -1
    v_mov_b32 v139, -1
    v_mov_b32 v140, -1
    v_mov_b32 v141, -1
    v_mov_b32 v142, -1
    v_mov_b32 v143, -1
    v_mov_b32 v144, -1
    v_mov_b32 v145, -1
    v_mov_b32 v146, -1
    v_mov_b32 v147, -1
    v_mov_b32 v148, -1
    v_mov_b32 v149, -1
    v_mov_b32 v150, -1
    v_mov_b32 v151, -1
    v_mov_b32 v152, -1
    v_mov_b32 v153, -1
    v_mov_b32 v154, -1
    v_mov_b32 v155, -1
    v_mov_b32 v156, -1
    v_mov_b32 v157, -1
    v_mov_b32 v158, -1
    v_mov_b32 v159, -1
    v_mov_b32 v160, -1
    v_mov_b32 v161, -1
    s_mov_b32 s84, s24
    s_and_b32 s85, s25, 0xffff
    s_mov_b32 s86, 0x400000
    s_mov_b32 s87, 0x00020000
    s_mov_b32 s64, s34
    s_and_b32 s65, s35, 0xffff
    s_mov_b32 s66, 0x1000
    s_mov_b32 s67, 0x00020000
    s_mov_b32 s56, s28
    s_and_b32 s57, s29, 0xffff
    s_mov_b32 s58, 0x1c0000
    s_mov_b32 s59, 0x00020000
    s_mul_i32 s95, s70, 16384
    s_add_u32 s95, s95, 14848
    v_lshrrev_b32 v60, 2, v1
    v_lshl_add_u32 v60, v2, 3, v60
    v_and_b32 v4, 3, v1
    v_lshlrev_b32 v4, 3, v4
    v_lshl_or_b32 v60, v60, 7, v4
    v_add_u32 v60, s69, v60
    v_lshrrev_b32 v234, 2, v1
    v_lshl_add_u32 v234, v2, 3, v234
    v_and_b32 v4, 3, v1
    v_lshlrev_b32 v4, 3, v4
    v_lshl_or_b32 v234, v234, 6, v4
    v_add_u32 v234, s69, v234
    v_lshrrev_b32 v235, 2, v1
    v_lshl_add_u32 v235, v2, 3, v235
    v_and_b32 v4, 3, v1
    v_lshlrev_b32 v4, 3, v4
    v_lshl_or_b32 v235, v235, 8, v4
    v_add_u32 v235, s95, v235
    v_lshrrev_b32 v4, 3, v0
    v_and_b32 v5, 7, v0
    v_lshlrev_b32 v5, 4, v5
    v_lshl_or_b32 v62, v4, 10, v5
    s_movk_i32 s78, 3584
    v_lshrrev_b32 v4, 2, v0
    v_mul_lo_u32 v4, v4, s78
    v_and_b32 v5, 3, v0
    v_lshl_add_u32 v61, v5, 4, v4
    v_lshlrev_b32 v63, 4, v1
    v_lshl_or_b32 v63, v2, 10, v63
    s_and_b32 s94, s75, 2
    v_lshrrev_b32 v5, 5, v0
    v_and_b32 v6, 31, v0
    v_lshlrev_b32 v4, 3, v6
    v_lshl_or_b32 v233, v5, 14, v4
    v_lshl_or_b32 v4, v5, 10, v4
    s_lshl_b32 s78, s94, 10
    s_lshl_b32 s79, s70, 8
    s_add_u32 s78, s78, s79
    buffer_load_dwordx2 v[58:59], v4, s[60:63], s78 offen
    v_lshlrev_b32 v57, 3, v0
    s_lshl_b32 s78, s70, 9
    s_add_u32 s78, s78, 5120
    v_lshlrev_b32 v56, 4, v2
    v_add_u32 v56, s78, v56
    v_and_b32 v224, 1, v1
    v_lshl_add_u32 v224, v224, 8, v56
    v_add_u32 v225, s78, v57
    v_lshlrev_b32 v226, 1, v6
    v_lshl_or_b32 v226, v5, 8, v226
    v_add_u32 v226, s78, v226
    s_lshl_b32 s78, s70, 8
    v_lshlrev_b32 v54, 4, v2
    v_add_u32 v54, s78, v54
    v_subrev_u32 v227, 5120, v224
    v_lshlrev_b32 v55, 2, v6
    v_lshl_or_b32 v228, v5, 8, v55
    v_lshlrev_b32 v229, 4, v6
    v_lshl_or_b32 v229, v5, 14, v229
    s_lshl_b32 s78, s70, 9
    v_lshlrev_b32 v230, 4, v6
    v_add_u32 v230, s78, v230
    v_mul_u32_u24 v237, 196608, v5
    v_add_u32 v236, v237, v230
    v_lshl_or_b32 v230, v5, 11, v230
    v_and_b32 v7, 7, v0
    v_mul_u32_u24 v7, 3072, v7
    s_lshl_b32 s78, s70, 3
    v_add3_u32 v237, v237, v7, s78
    v_lshlrev_b32 v232, 5, v5
    v_add_u32 v231, s78, v232
    v_and_b32 v53, 1, v1
    v_mul_u32_u24 v53, 114688, v53
    v_lshl_add_u32 v53, v2, 4, v53
    s_mul_i32 s79, s70, 16384
    s_add_u32 s79, s79, 23936
    v_lshrrev_b32 v7, 1, v1
    v_lshl_add_u32 v250, v7, 6, v53
    v_and_b32 v248, 1, v1
    v_lshlrev_b32 v248, 6, v248
    v_lshl_add_u32 v248, v2, 4, v248
    v_add_u32 v248, s79, v248
    v_lshlrev_b32 v7, 7, v7
    v_sub_u32 v248, v248, v7
    v_lshlrev_b32 v249, 1, v0
    v_add_u32 v249, s79, v249
    v_lshrrev_b32 v251, 5, v0
    v_bfe_u32 v7, v0, 4, 1
    v_lshl_or_b32 v251, v7, 1, v251
    v_bfe_u32 v7, v0, 3, 1
    v_lshlrev_b32 v226, 1, v251
    v_lshl_or_b32 v226, v7, 10, v226
    v_lshlrev_b32 v251, 1, v226
    v_min_u32 v52, 55, v0
    v_lshlrev_b32 v52, 11, v52
    s_lshl_b32 s78, s70, 9
    s_lshl_b32 s79, s70, 5
    s_add_u32 s80, s78, 0x2a00
    s_add_u32 s81, s79, 0x2a00
    v_add_u32 v238, s80, v57
    v_mov_b32 v242, s81
    s_add_u32 s80, s78, 0x6a00
    s_add_u32 s81, s79, 0x6a00
    v_add_u32 v239, s80, v57
    v_mov_b32 v243, s81
    s_add_u32 s80, s78, 0xaa00
    s_add_u32 s81, s79, 0xaa00
    v_add_u32 v240, s80, v57
    v_mov_b32 v244, s81
    s_add_u32 s80, s78, 0xea00
    s_add_u32 s81, s79, 0xea00
    v_add_u32 v241, s80, v57
    v_mov_b32 v245, s81
    v_add_u32 v246, s78, v57
    s_lshl_b32 s80, s70, 3
    v_mov_b32 v247, s80
    s_cmp_lg_u32 s70, 1
    s_cbranch_scc1 L_noflagchk
    s_cmp_ge_u32 s77, 56
    s_cbranch_scc1 L_noflagchk
    v_and_b32 v4, 7, v0
    v_lshlrev_b32 v4, 2, v4
    s_mov_b32 s96, 100000
L_af_7:
    buffer_load_dword v6, v4, s[52:55], 0 offen offset:128 sc1
    s_waitcnt vmcnt(0)
    v_and_b32 v252, v6, v6
    v_cmp_ne_u32 vcc, 0x1, v252
    s_cbranch_vccz L_afd_8
    s_sub_u32 s96, s96, 1
    s_cmp_eq_u32 s96, 0
    s_cbranch_scc1 L_afd_8
    s_sleep 32
    s_branch L_af_7
L_afd_8:
L_noflagchk:
    s_waitcnt vmcnt(0)
    s_mov_b32 s52, s30
    s_and_b32 s53, s31, 0xffff
    s_mov_b32 s54, 0x1c0000
    s_mov_b32 s55, 0x00020000
    s_mov_b32 s60, s32
    s_and_b32 s61, s33, 0xffff
    s_mov_b32 s62, 0x1c0000
    s_mov_b32 s63, 0x00020000
    s_cmp_lg_u32 s70, 3
    s_cbranch_scc1 L_afterdry
    s_mov_b64 s[40:41], 0
    s_mov_b64 s[42:43], 0
    s_mov_b64 s[44:45], 0
    s_mov_b64 s[46:47], 0
    s_mov_b64 s[30:31], 0
    s_mov_b64 s[28:29], 0
    s_mov_b32 s97, 1
    s_mov_b32 s70, 0
    s_mov_b64 exec, 0
    s_branch L_tail
L_afterdry:
    s_sub_u32 s70, s68, 4
    s_mov_b32 s97, 0
    s_mov_b64 s[40:41], -1
    s_mov_b64 s[42:43], 1
    s_mov_b32 s44, 0x00010001
    s_mov_b32 s45, 0x00010001
    s_mov_b32 s30, 0x00030003
    s_mov_b32 s31, 0x00030003
    s_mov_b32 s28, 1
    s_mov_b32 s29, 1
    s_mov_b32 s46, 0x1010101
    s_mov_b32 s47, 0x1010101
    s_mov_b64 exec, -1
    s_waitcnt vmcnt(0) lgkmcnt(0)
    s_barrier
L_tail:
    ds_read_b128 v[16:19], v242 offset:2048
    ds_read_b128 v[20:23], v242 offset:2064
    ds_read_b128 v[24:27], v243 offset:2048
    ds_read_b128 v[28:31], v243 offset:2064
    ds_read_b128 v[32:35], v244 offset:2048
    ds_read_b128 v[36:39], v244 offset:2064
    ds_read_b128 v[40:43], v245 offset:2048
    ds_read_b128 v[44:47], v245 offset:2064
    ds_read_b64 v[8:9], v238
    ds_read_b64 v[10:11], v239
    ds_read_b64 v[12:13], v240
    ds_read_b64 v[14:15], v241
    s_lshl_b32 s78, s76, 3
    s_add_u32 s79, s78, s74
    s_mul_i32 s79, s79, 3072
    s_add_u32 s79, s79, 65536
    s_waitcnt lgkmcnt(4)
    v_max_f32 v48, v16, v24
    v_max3_f32 v48, v48, v32, v40
    v_sub_f32 v16, v16, v48
    v_mul_f32 v16, s72, v16
    v_exp_f32 v16, v16
    v_add_f32 v17, v17, v19
    v_add_f32 v21, v21, v23
    v_add_f32 v17, v17, v21
    v_sub_f32 v24, v24, v48
    v_mul_f32 v24, s72, v24
    v_exp_f32 v24, v24
    v_add_f32 v25, v25, v27
    v_add_f32 v29, v29, v31
    v_add_f32 v25, v25, v29
    v_sub_f32 v32, v32, v48
    v_mul_f32 v32, s72, v32
    v_exp_f32 v32, v32
    v_add_f32 v33, v33, v35
    v_add_f32 v37, v37, v39
    v_add_f32 v33, v33, v37
    v_sub_f32 v40, v40, v48
    v_mul_f32 v40, s72, v40
    v_exp_f32 v40, v40
    v_add_f32 v41, v41, v43
    v_add_f32 v45, v45, v47
    v_add_f32 v41, v41, v45
    s_waitcnt lgkmcnt(0)
    v_mul_f32 v50, v16, v8
    v_mul_f32 v51, v16, v9
    v_fma_f32 v50, v24, v10, v50
    v_fma_f32 v51, v24, v11, v51
    v_fma_f32 v50, v32, v12, v50
    v_fma_f32 v51, v32, v13, v51
    v_fma_f32 v50, v40, v14, v50
    v_fma_f32 v51, v40, v15, v51
    v_and_b32 v50, -2, v50
    v_and_b32 v51, -2, v51
    buffer_store_dwordx2 v[50:51], v246, s[48:51], s79 offen sc1
    v_mul_f32 v49, v16, v17
    v_fma_f32 v49, v24, v25, v49
    v_fma_f32 v49, v32, v33, v49
    v_fma_f32 v49, v40, v41, v49
    v_and_b32 v49, -2, v49
    v_and_b32 v48, -2, v48
    s_mov_b64 exec, s[42:43]
    buffer_store_dwordx2 v[48:49], v247, s[48:51], s79 offen offset:2048 sc1
    s_mov_b64 exec, s[40:41]
    s_cmp_lt_u32 s77, 56
    s_cbranch_scc1 L_ffn
    s_cmp_lg_u32 s77, 62
    s_cbranch_scc1 L_tailend
    s_cmp_lg_u32 s97, 0
    s_cbranch_scc1 L_nd_9
    s_lshl_b32 s80, s73, 19
    s_lshl_b32 s81, s70, 17
    s_add_u32 s80, s80, s81
    s_lshl_b32 s81, s101, 7
    s_add_u32 s80, s80, s81
    s_add_u32 m0, s69, 0
    s_mov_b32 s93, s80
    buffer_load_dwordx4 v62, s[84:87], s93 offen nt lds
    s_add_u32 m0, s69, 1024
    s_add_u32 s93, s93, 8192
    buffer_load_dwordx4 v62, s[84:87], s93 offen nt lds
    s_add_u32 m0, s69, 2048
    s_add_u32 s93, s93, 8192
    buffer_load_dwordx4 v62, s[84:87], s93 offen nt lds
    s_add_u32 m0, s69, 3072
    s_add_u32 s93, s93, 8192
    buffer_load_dwordx4 v62, s[84:87], s93 offen nt lds
    s_add_u32 m0, s69, 4096
    s_add_u32 s93, s93, 8192
    buffer_load_dwordx4 v62, s[84:87], s93 offen nt lds
    s_add_u32 m0, s69, 5120
    s_add_u32 s93, s93, 8192
    buffer_load_dwordx4 v62, s[84:87], s93 offen nt lds
    s_add_u32 m0, s69, 6144
    s_add_u32 s93, s93, 8192
    buffer_load_dwordx4 v62, s[84:87], s93 offen nt lds
    s_add_u32 m0, s69, 7168
    s_add_u32 s93, s93, 8192
    buffer_load_dwordx4 v62, s[84:87], s93 offen nt lds
    s_add_u32 m0, s69, 8192
    s_add_u32 s93, s93, 8192
    buffer_load_dwordx4 v62, s[84:87], s93 offen nt lds
    s_add_u32 m0, s69, 9216
    s_add_u32 s93, s93, 8192
    buffer_load_dwordx4 v62, s[84:87], s93 offen nt lds
    s_add_u32 m0, s69, 10240
    s_add_u32 s93, s93, 8192
    buffer_load_dwordx4 v62, s[84:87], s93 offen nt lds
    s_add_u32 m0, s69, 11264
    s_add_u32 s93, s93, 8192
    buffer_load_dwordx4 v62, s[84:87], s93 offen nt lds
    s_add_u32 m0, s69, 12288
    s_add_u32 s93, s93, 8192
    buffer_load_dwordx4 v62, s[84:87], s93 offen nt lds
    s_add_u32 m0, s69, 13312
    s_add_u32 s93, s93, 8192
    buffer_load_dwordx4 v62, s[84:87], s93 offen nt lds
    s_add_u32 m0, s69, 14336
    s_add_u32 s93, s93, 8192
    buffer_load_dwordx4 v62, s[84:87], s93 offen nt lds
    s_add_u32 m0, s69, 15360
    s_add_u32 s93, s93, 8192
    buffer_load_dwordx4 v62, s[84:87], s93 offen nt lds
L_nd_9:
    s_lshl_b32 s78, s94, 3
    s_add_u32 s78, s78, s73
    s_mul_i32 s88, s78, 24576
    s_add_u32 s88, s88, 65536
    s_add_u32 s89, s88, 6144
    s_add_u32 s90, s88, 12288
    s_add_u32 s91, s88, 18432
    s_mov_b32 s96, 100000
    buffer_load_dwordx4 v[128:131], v236, s[48:51], s88 offen offset:0 sc1
    buffer_load_dwordx4 v[132:135], v236, s[48:51], s88 offen offset:3072 sc1
    buffer_load_dwordx4 v[136:139], v236, s[48:51], s89 offen offset:0 sc1
    buffer_load_dwordx4 v[140:143], v236, s[48:51], s89 offen offset:3072 sc1
    buffer_load_dwordx4 v[144:147], v236, s[48:51], s90 offen offset:0 sc1
    buffer_load_dwordx4 v[148:151], v236, s[48:51], s90 offen offset:3072 sc1
    buffer_load_dwordx4 v[152:155], v236, s[48:51], s91 offen offset:0 sc1
    buffer_load_dwordx4 v[156:159], v236, s[48:51], s91 offen offset:3072 sc1
    buffer_load_dwordx2 v[160:161], v237, s[48:51], s88 offen offset:2048 sc1
    s_waitcnt vmcnt(0)
    ds_read_b64_tr_b16 v[64:65], v60 offset:0
    ds_read_b64_tr_b16 v[66:67], v60 offset:512
    ds_read_b64_tr_b16 v[68:69], v60 offset:32
    ds_read_b64_tr_b16 v[70:71], v60 offset:544
    ds_read_b64_tr_b16 v[72:73], v60 offset:64
    ds_read_b64_tr_b16 v[74:75], v60 offset:576
    ds_read_b64_tr_b16 v[76:77], v60 offset:96
    ds_read_b64_tr_b16 v[78:79], v60 offset:608
    ds_read_b64_tr_b16 v[80:81], v60 offset:4096
    ds_read_b64_tr_b16 v[82:83], v60 offset:4608
    ds_read_b64_tr_b16 v[84:85], v60 offset:4128
    ds_read_b64_tr_b16 v[86:87], v60 offset:4640
    ds_read_b64_tr_b16 v[88:89], v60 offset:4160
    ds_read_b64_tr_b16 v[90:91], v60 offset:4672
    ds_read_b64_tr_b16 v[92:93], v60 offset:4192
    ds_read_b64_tr_b16 v[94:95], v60 offset:4704
    ds_read_b64_tr_b16 v[96:97], v60 offset:8192
    ds_read_b64_tr_b16 v[98:99], v60 offset:8704
    ds_read_b64_tr_b16 v[100:101], v60 offset:8224
    ds_read_b64_tr_b16 v[102:103], v60 offset:8736
    ds_read_b64_tr_b16 v[104:105], v60 offset:8256
    ds_read_b64_tr_b16 v[106:107], v60 offset:8768
    ds_read_b64_tr_b16 v[108:109], v60 offset:8288
    ds_read_b64_tr_b16 v[110:111], v60 offset:8800
    ds_read_b64_tr_b16 v[112:113], v60 offset:12288
    ds_read_b64_tr_b16 v[114:115], v60 offset:12800
    ds_read_b64_tr_b16 v[116:117], v60 offset:12320
    ds_read_b64_tr_b16 v[118:119], v60 offset:12832
    ds_read_b64_tr_b16 v[120:121], v60 offset:12352
    ds_read_b64_tr_b16 v[122:123], v60 offset:12864
    ds_read_b64_tr_b16 v[124:125], v60 offset:12384
    ds_read_b64_tr_b16 v[126:127], v60 offset:12896
    v_max3_u32 v252, v128, v129, v130
    v_max_u32 v252, v252, v131
    v_cmp_eq_u32 s[20:21], -1, v252
    v_max3_u32 v253, v132, v133, v134
    v_max_u32 v253, v253, v135
    v_cmp_eq_u32 s[22:23], -1, v253
    v_max3_u32 v252, v136, v137, v138
    v_max_u32 v252, v252, v139
    v_cmp_eq_u32 s[24:25], -1, v252
    v_max3_u32 v253, v140, v141, v142
    v_max_u32 v253, v253, v143
    v_cmp_eq_u32 s[26:27], -1, v253
    v_max3_u32 v252, v144, v145, v146
    v_max_u32 v252, v252, v147
    v_cmp_eq_u32 s[32:33], -1, v252
    v_max3_u32 v253, v148, v149, v150
    v_max_u32 v253, v253, v151
    v_cmp_eq_u32 s[34:35], -1, v253
    v_max3_u32 v252, v152, v153, v154
    v_max_u32 v252, v252, v155
    v_cmp_eq_u32 s[36:37], -1, v252
    v_max3_u32 v253, v156, v157, v158
    v_max_u32 v253, v253, v159
    v_cmp_eq_u32 s[38:39], -1, v253
    v_max_u32 v252, v160, v161
    v_cmp_eq_u32 s[82:83], -1, v252
    s_bcnt1_i32_b64 s92, s[20:21]
    s_bcnt1_i32_b64 s93, s[22:23]
    s_add_u32 s92, s92, s93
    s_bcnt1_i32_b64 s93, s[24:25]
    s_add_u32 s92, s92, s93
    s_bcnt1_i32_b64 s93, s[26:27]
    s_add_u32 s92, s92, s93
    s_bcnt1_i32_b64 s93, s[32:33]
    s_add_u32 s92, s92, s93
    s_bcnt1_i32_b64 s93, s[34:35]
    s_add_u32 s92, s92, s93
    s_bcnt1_i32_b64 s93, s[36:37]
    s_add_u32 s92, s92, s93
    s_bcnt1_i32_b64 s93, s[38:39]
    s_add_u32 s92, s92, s93
    s_bcnt1_i32_b64 s93, s[82:83]
    s_add_u32 s92, s92, s93
    s_cmp_eq_u32 s92, 0
    s_cbranch_scc1 L_h1d_12
L_h1_10:
    s_mov_b64 exec, s[20:21]
    buffer_load_dwordx4 v[128:131], v236, s[48:51], s88 offen offset:0 sc1
    s_mov_b64 exec, s[22:23]
    buffer_load_dwordx4 v[132:135], v236, s[48:51], s88 offen offset:3072 sc1
    s_mov_b64 exec, s[24:25]
    buffer_load_dwordx4 v[136:139], v236, s[48:51], s89 offen offset:0 sc1
    s_mov_b64 exec, s[26:27]
    buffer_load_dwordx4 v[140:143], v236, s[48:51], s89 offen offset:3072 sc1
    s_mov_b64 exec, s[32:33]
    buffer_load_dwordx4 v[144:147], v236, s[48:51], s90 offen offset:0 sc1
    s_mov_b64 exec, s[34:35]
    buffer_load_dwordx4 v[148:151], v236, s[48:51], s90 offen offset:3072 sc1
    s_mov_b64 exec, s[36:37]
    buffer_load_dwordx4 v[152:155], v236, s[48:51], s91 offen offset:0 sc1
    s_mov_b64 exec, s[38:39]
    buffer_load_dwordx4 v[156:159], v236, s[48:51], s91 offen offset:3072 sc1
    s_mov_b64 exec, s[82:83]
    buffer_load_dwordx2 v[160:161], v237, s[48:51], s88 offen offset:2048 sc1
    s_mov_b64 exec, s[40:41]
    s_cmp_le_u32 s92, 80
    s_cbranch_scc1 L_h1f_11
    s_waitcnt vmcnt(0)
L_h1f_11:
    s_waitcnt vmcnt(45)
    v_max3_u32 v252, v128, v129, v130
    v_max_u32 v252, v252, v131
    v_cmp_eq_u32 s[20:21], -1, v252
    v_max3_u32 v253, v132, v133, v134
    v_max_u32 v253, v253, v135
    v_cmp_eq_u32 s[22:23], -1, v253
    v_max3_u32 v252, v136, v137, v138
    v_max_u32 v252, v252, v139
    v_cmp_eq_u32 s[24:25], -1, v252
    v_max3_u32 v253, v140, v141, v142
    v_max_u32 v253, v253, v143
    v_cmp_eq_u32 s[26:27], -1, v253
    v_max3_u32 v252, v144, v145, v146
    v_max_u32 v252, v252, v147
    v_cmp_eq_u32 s[32:33], -1, v252
    v_max3_u32 v253, v148, v149, v150
    v_max_u32 v253, v253, v151
    v_cmp_eq_u32 s[34:35], -1, v253
    v_max3_u32 v252, v152, v153, v154
    v_max_u32 v252, v252, v155
    v_cmp_eq_u32 s[36:37], -1, v252
    v_max3_u32 v253, v156, v157, v158
    v_max_u32 v253, v253, v159
    v_cmp_eq_u32 s[38:39], -1, v253
    v_max_u32 v252, v160, v161
    v_cmp_eq_u32 s[82:83], -1, v252
    s_bcnt1_i32_b64 s92, s[20:21]
    s_bcnt1_i32_b64 s93, s[22:23]
    s_add_u32 s92, s92, s93
    s_bcnt1_i32_b64 s93, s[24:25]
    s_add_u32 s92, s92, s93
    s_bcnt1_i32_b64 s93, s[26:27]
    s_add_u32 s92, s92, s93
    s_bcnt1_i32_b64 s93, s[32:33]
    s_add_u32 s92, s92, s93
    s_bcnt1_i32_b64 s93, s[34:35]
    s_add_u32 s92, s92, s93
    s_bcnt1_i32_b64 s93, s[36:37]
    s_add_u32 s92, s92, s93
    s_bcnt1_i32_b64 s93, s[38:39]
    s_add_u32 s92, s92, s93
    s_bcnt1_i32_b64 s93, s[82:83]
    s_add_u32 s92, s92, s93
    s_cmp_eq_u32 s92, 0
    s_cbranch_scc1 L_h1d_12
    s_sub_u32 s96, s96, 1
    s_cmp_eq_u32 s96, 0
    s_cbranch_scc1 L_h1d_12
    s_sleep 1
    s_branch L_h1_10
L_h1d_12:
    v_max_f32_dpp v8, v160, v160 row_ror:4 row_mask:0xf bank_mask:0xf
    s_nop 1
    v_max_f32_dpp v8, v8, v8 row_ror:2 row_mask:0xf bank_mask:0xf
    s_nop 1
    v_max_f32_dpp v8, v8, v8 row_ror:1 row_mask:0xf bank_mask:0xf
    v_sub_f32 v9, v160, v8
    v_mul_f32 v9, s72, v9
    v_exp_f32 v9, v9
    s_nop 0
    v_mul_f32 v10, v9, v161
    s_nop 1
    v_add_f32_dpp v10, v10, v10 row_ror:4 row_mask:0xf bank_mask:0xf
    s_nop 1
    v_add_f32_dpp v10, v10, v10 row_ror:2 row_mask:0xf bank_mask:0xf
    s_nop 1
    v_add_f32_dpp v10, v10, v10 row_ror:1 row_mask:0xf bank_mask:0xf
    v_rcp_f32 v10, v10
    s_nop 0
    v_mul_f32 v9, v9, v10
    s_nop 1
    v_mov_b32_dpp v16, v9 row_newbcast:0 row_mask:0xf bank_mask:0xf
    v_mov_b32_dpp v17, v9 row_newbcast:1 row_mask:0xf bank_mask:0xf
    v_mov_b32_dpp v18, v9 row_newbcast:2 row_mask:0xf bank_mask:0xf
    v_mov_b32_dpp v19, v9 row_newbcast:3 row_mask:0xf bank_mask:0xf
    v_mov_b32_dpp v20, v9 row_newbcast:4 row_mask:0xf bank_mask:0xf
    v_mov_b32_dpp v21, v9 row_newbcast:5 row_mask:0xf bank_mask:0xf
    v_mov_b32_dpp v22, v9 row_newbcast:6 row_mask:0xf bank_mask:0xf
    v_mov_b32_dpp v23, v9 row_newbcast:7 row_mask:0xf bank_mask:0xf
    v_pk_mul_f32 v[8:9], v[128:129], v[16:17] op_sel:[0,0] op_sel_hi:[1,0]
    v_pk_mul_f32 v[10:11], v[130:131], v[16:17] op_sel:[0,0] op_sel_hi:[1,0]
    v_pk_mul_f32 v[12:13], v[132:133], v[16:17] op_sel:[0,1] op_sel_hi:[1,1]
    v_pk_mul_f32 v[14:15], v[134:135], v[16:17] op_sel:[0,1] op_sel_hi:[1,1]
    v_pk_fma_f32 v[8:9], v[136:137], v[18:19], v[8:9] op_sel:[0,0,0] op_sel_hi:[1,0,1]
    v_pk_fma_f32 v[10:11], v[138:139], v[18:19], v[10:11] op_sel:[0,0,0] op_sel_hi:[1,0,1]
    v_pk_fma_f32 v[12:13], v[140:141], v[18:19], v[12:13] op_sel:[0,1,0] op_sel_hi:[1,1,1]
    v_pk_fma_f32 v[14:15], v[142:143], v[18:19], v[14:15] op_sel:[0,1,0] op_sel_hi:[1,1,1]
    v_pk_fma_f32 v[8:9], v[144:145], v[20:21], v[8:9] op_sel:[0,0,0] op_sel_hi:[1,0,1]
    v_pk_fma_f32 v[10:11], v[146:147], v[20:21], v[10:11] op_sel:[0,0,0] op_sel_hi:[1,0,1]
    v_pk_fma_f32 v[12:13], v[148:149], v[20:21], v[12:13] op_sel:[0,1,0] op_sel_hi:[1,1,1]
    v_pk_fma_f32 v[14:15], v[150:151], v[20:21], v[14:15] op_sel:[0,1,0] op_sel_hi:[1,1,1]
    v_pk_fma_f32 v[8:9], v[152:153], v[22:23], v[8:9] op_sel:[0,0,0] op_sel_hi:[1,0,1]
    v_pk_fma_f32 v[10:11], v[154:155], v[22:23], v[10:11] op_sel:[0,0,0] op_sel_hi:[1,0,1]
    v_pk_fma_f32 v[12:13], v[156:157], v[22:23], v[12:13] op_sel:[0,1,0] op_sel_hi:[1,1,1]
    v_pk_fma_f32 v[14:15], v[158:159], v[22:23], v[14:15] op_sel:[0,1,0] op_sel_hi:[1,1,1]
    v_pk_add_f32 v[8:9], v[8:9], v[12:13]
    v_pk_add_f32 v[10:11], v[10:11], v[14:15]
    v_cvt_pk_bf16_f32 v50, v8, v9
    v_cvt_pk_bf16_f32 v51, v10, v11
    ds_write_b64 v225, v[50:51]
    ds_read_b128 v[8:11], v224 offset:0
    ds_read_b128 v[12:15], v224 offset:64
    ds_read_b128 v[16:19], v224 offset:128
    ds_read_b128 v[20:23], v224 offset:192
    s_lshl_b32 s78, s94, 14
    s_lshl_b32 s79, s73, 11
    s_add_u32 s78, s78, s79
    s_lshl_b32 s79, s101, 8
    s_add_u32 s78, s78, s79
    s_add_u32 s78, s78, 1048576
    s_waitcnt lgkmcnt(3)
    v_mfma_f32_16x16x32_bf16 v[24:27], v[64:67], v[8:11], 0
    v_mfma_f32_16x16x32_bf16 v[28:31], v[68:71], v[8:11], 0
    v_mfma_f32_16x16x32_bf16 v[32:35], v[72:75], v[8:11], 0
    v_mfma_f32_16x16x32_bf16 v[36:39], v[76:79], v[8:11], 0
    s_waitcnt lgkmcnt(2)
    v_mfma_f32_16x16x32_bf16 v[24:27], v[80:83], v[12:15], v[24:27]
    v_mfma_f32_16x16x32_bf16 v[28:31], v[84:87], v[12:15], v[28:31]
    v_mfma_f32_16x16x32_bf16 v[32:35], v[88:91], v[12:15], v[32:35]
    v_mfma_f32_16x16x32_bf16 v[36:39], v[92:95], v[12:15], v[36:39]
    s_waitcnt lgkmcnt(1)
    v_mfma_f32_16x16x32_bf16 v[24:27], v[96:99], v[16:19], v[24:27]
    v_mfma_f32_16x16x32_bf16 v[28:31], v[100:103], v[16:19], v[28:31]
    v_mfma_f32_16x16x32_bf16 v[32:35], v[104:107], v[16:19], v[32:35]
    v_mfma_f32_16x16x32_bf16 v[36:39], v[108:111], v[16:19], v[36:39]
    s_waitcnt lgkmcnt(0)
    v_mfma_f32_16x16x32_bf16 v[24:27], v[112:115], v[20:23], v[24:27]
    v_mfma_f32_16x16x32_bf16 v[28:31], v[116:119], v[20:23], v[28:31]
    v_mfma_f32_16x16x32_bf16 v[32:35], v[120:123], v[20:23], v[32:35]
    v_mfma_f32_16x16x32_bf16 v[36:39], v[124:127], v[20:23], v[36:39]
    s_mov_b64 exec, s[30:31]
    s_nop 4
    ds_write_b128 v227, v[24:27] offset:8192
    ds_write_b128 v227, v[28:31] offset:8256
    ds_write_b128 v227, v[32:35] offset:8320
    ds_write_b128 v227, v[36:39] offset:8384
    s_mov_b64 exec, s[40:41]
    s_waitcnt lgkmcnt(0)
    s_cmp_lg_u32 s97, 0
    s_cbranch_scc1 L_nb_13
    s_barrier
L_nb_13:
    s_cmp_lg_u32 s70, 0
    s_cbranch_scc1 L_noA2
    ds_read_b64 v[8:9], v57 offset:8192
    ds_read_b64 v[10:11], v57 offset:8704
    ds_read_b64 v[12:13], v57 offset:9216
    ds_read_b64 v[14:15], v57 offset:9728
    s_waitcnt lgkmcnt(2)
    v_pk_add_f32 v[8:9], v[8:9], v[10:11]
    s_waitcnt lgkmcnt(0)
    v_pk_add_f32 v[12:13], v[12:13], v[14:15]
    v_pk_add_f32 v[8:9], v[8:9], v[12:13]
    v_and_b32 v8, -2, v8
    v_and_b32 v9, -2, v9
    buffer_store_dwordx2 v[8:9], v233, s[48:51], s78 offen sc1
L_noA2:
    s_branch L_tailend
L_ffn:
    s_cmp_lg_u32 s97, 0
    s_cbranch_scc1 L_nd_14
    s_lshl_b32 s80, s77, 6
    s_mul_i32 s81, s70, 458752
    s_add_u32 s80, s80, s81
    s_add_u32 m0, s69, 0
    s_mov_b32 s93, s80
    buffer_load_dwordx4 v61, s[56:59], s93 offen nt lds
    s_add_u32 m0, s69, 1024
    s_add_u32 s93, s93, 57344
    buffer_load_dwordx4 v61, s[56:59], s93 offen nt lds
    s_add_u32 m0, s69, 2048
    s_add_u32 s93, s93, 57344
    buffer_load_dwordx4 v61, s[56:59], s93 offen nt lds
    s_add_u32 m0, s69, 3072
    s_add_u32 s93, s93, 57344
    buffer_load_dwordx4 v61, s[56:59], s93 offen nt lds
    s_add_u32 m0, s69, 4096
    s_add_u32 s93, s93, 57344
    buffer_load_dwordx4 v61, s[56:59], s93 offen nt lds
    s_add_u32 m0, s69, 5120
    s_add_u32 s93, s93, 57344
    buffer_load_dwordx4 v61, s[56:59], s93 offen nt lds
    s_add_u32 m0, s69, 6144
    s_add_u32 s93, s93, 57344
    buffer_load_dwordx4 v61, s[56:59], s93 offen nt lds
    s_add_u32 m0, s69, 7168
    s_add_u32 s93, s93, 57344
    buffer_load_dwordx4 v61, s[56:59], s93 offen nt lds
    s_add_u32 m0, s69, 8192
    s_mov_b32 s93, s80
    buffer_load_dwordx4 v61, s[52:55], s93 offen nt lds
    s_add_u32 m0, s69, 9216
    s_add_u32 s93, s93, 57344
    buffer_load_dwordx4 v61, s[52:55], s93 offen nt lds
    s_add_u32 m0, s69, 10240
    s_add_u32 s93, s93, 57344
    buffer_load_dwordx4 v61, s[52:55], s93 offen nt lds
    s_add_u32 m0, s69, 11264
    s_add_u32 s93, s93, 57344
    buffer_load_dwordx4 v61, s[52:55], s93 offen nt lds
    s_add_u32 m0, s69, 12288
    s_add_u32 s93, s93, 57344
    buffer_load_dwordx4 v61, s[52:55], s93 offen nt lds
    s_add_u32 m0, s69, 13312
    s_add_u32 s93, s93, 57344
    buffer_load_dwordx4 v61, s[52:55], s93 offen nt lds
    s_add_u32 m0, s69, 14336
    s_add_u32 s93, s93, 57344
    buffer_load_dwordx4 v61, s[52:55], s93 offen nt lds
    s_add_u32 m0, s69, 15360
    s_add_u32 s93, s93, 57344
    buffer_load_dwordx4 v61, s[52:55], s93 offen nt lds
    s_lshl_b32 s80, s77, 15
    s_lshl_b32 s81, s70, 8
    s_add_u32 s80, s80, s81
    s_add_u32 m0, s95, 0
    s_mov_b32 s93, s80
    buffer_load_dwordx4 v63, s[60:63], s93 offen nt lds
    s_add_u32 m0, s95, 1024
    s_add_u32 s93, s93, 4096
    buffer_load_dwordx4 v63, s[60:63], s93 offen nt lds
    s_add_u32 m0, s95, 2048
    s_add_u32 s93, s93, 4096
    buffer_load_dwordx4 v63, s[60:63], s93 offen nt lds
    s_add_u32 m0, s95, 3072
    s_add_u32 s93, s93, 4096
    buffer_load_dwordx4 v63, s[60:63], s93 offen nt lds
    s_add_u32 m0, s95, 4096
    s_add_u32 s93, s93, 4096
    buffer_load_dwordx4 v63, s[60:63], s93 offen nt lds
    s_add_u32 m0, s95, 5120
    s_add_u32 s93, s93, 4096
    buffer_load_dwordx4 v63, s[60:63], s93 offen nt lds
    s_add_u32 m0, s95, 6144
    s_add_u32 s93, s93, 4096
    buffer_load_dwordx4 v63, s[60:63], s93 offen nt lds
    s_add_u32 m0, s95, 7168
    s_add_u32 s93, s93, 4096
    buffer_load_dwordx4 v63, s[60:63], s93 offen nt lds
L_nd_14:
    s_lshl_b32 s78, s94, 14
    s_lshl_b32 s79, s70, 9
    s_add_u32 s78, s78, s79
    s_add_u32 s88, s78, 1048576
    s_add_u32 s89, s88, 4096
    s_add_u32 s90, s88, 8192
    s_add_u32 s91, s88, 12288
    v_mov_b32 v8, 0
    v_mov_b32 v9, 0
    v_mov_b32 v10, 0
    v_mov_b32 v11, 0
    s_mul_i32 s78, s70, 16384
    s_add_u32 s78, s78, 23040
    v_add_u32 v12, s78, v3
    ds_write_b128 v12, v[8:11]
    ds_write_b128 v12, v[8:11] offset:1024
    s_waitcnt vmcnt(8)
    ds_read_b64_tr_b16 v[128:129], v234 offset:0
    ds_read_b64_tr_b16 v[130:131], v234 offset:256
    ds_read_b64_tr_b16 v[132:133], v234 offset:32
    ds_read_b64_tr_b16 v[134:135], v234 offset:288
    ds_read_b64_tr_b16 v[136:137], v234 offset:8192
    ds_read_b64_tr_b16 v[138:139], v234 offset:8448
    ds_read_b64_tr_b16 v[140:141], v234 offset:8224
    ds_read_b64_tr_b16 v[142:143], v234 offset:8480
    ds_read_b64_tr_b16 v[144:145], v234 offset:2048
    ds_read_b64_tr_b16 v[146:147], v234 offset:2304
    ds_read_b64_tr_b16 v[148:149], v234 offset:2080
    ds_read_b64_tr_b16 v[150:151], v234 offset:2336
    ds_read_b64_tr_b16 v[152:153], v234 offset:10240
    ds_read_b64_tr_b16 v[154:155], v234 offset:10496
    ds_read_b64_tr_b16 v[156:157], v234 offset:10272
    ds_read_b64_tr_b16 v[158:159], v234 offset:10528
    ds_read_b64_tr_b16 v[160:161], v234 offset:4096
    ds_read_b64_tr_b16 v[162:163], v234 offset:4352
    ds_read_b64_tr_b16 v[164:165], v234 offset:4128
    ds_read_b64_tr_b16 v[166:167], v234 offset:4384
    ds_read_b64_tr_b16 v[168:169], v234 offset:12288
    ds_read_b64_tr_b16 v[170:171], v234 offset:12544
    ds_read_b64_tr_b16 v[172:173], v234 offset:12320
    ds_read_b64_tr_b16 v[174:175], v234 offset:12576
    ds_read_b64_tr_b16 v[176:177], v234 offset:6144
    ds_read_b64_tr_b16 v[178:179], v234 offset:6400
    ds_read_b64_tr_b16 v[180:181], v234 offset:6176
    ds_read_b64_tr_b16 v[182:183], v234 offset:6432
    ds_read_b64_tr_b16 v[184:185], v234 offset:14336
    ds_read_b64_tr_b16 v[186:187], v234 offset:14592
    ds_read_b64_tr_b16 v[188:189], v234 offset:14368
    ds_read_b64_tr_b16 v[190:191], v234 offset:14624
    v_mov_b32 v8, 0x3f803f80
    v_mov_b32 v9, 0x3f803f80
    v_mov_b32 v10, 0x3f803f80
    v_mov_b32 v11, 0x3f803f80
    s_waitcnt lgkmcnt(0)
    v_mfma_f32_16x16x32_bf16 v[24:27], v[128:131], v[8:11], 0
    v_mfma_f32_16x16x32_bf16 v[28:31], v[132:135], v[8:11], 0
    v_mfma_f32_16x16x32_bf16 v[32:35], v[136:139], v[8:11], 0
    v_mfma_f32_16x16x32_bf16 v[36:39], v[140:143], v[8:11], 0
    v_mfma_f32_16x16x32_bf16 v[24:27], v[144:147], v[8:11], v[24:27]
    v_mfma_f32_16x16x32_bf16 v[28:31], v[148:151], v[8:11], v[28:31]
    v_mfma_f32_16x16x32_bf16 v[32:35], v[152:155], v[8:11], v[32:35]
    v_mfma_f32_16x16x32_bf16 v[36:39], v[156:159], v[8:11], v[36:39]
    v_mfma_f32_16x16x32_bf16 v[24:27], v[160:163], v[8:11], v[24:27]
    v_mfma_f32_16x16x32_bf16 v[28:31], v[164:167], v[8:11], v[28:31]
    v_mfma_f32_16x16x32_bf16 v[32:35], v[168:171], v[8:11], v[32:35]
    v_mfma_f32_16x16x32_bf16 v[36:39], v[172:175], v[8:11], v[36:39]
    v_mfma_f32_16x16x32_bf16 v[24:27], v[176:179], v[8:11], v[24:27]
    v_mfma_f32_16x16x32_bf16 v[28:31], v[180:183], v[8:11], v[28:31]
    v_mfma_f32_16x16x32_bf16 v[32:35], v[184:187], v[8:11], v[32:35]
    v_mfma_f32_16x16x32_bf16 v[36:39], v[188:191], v[8:11], v[36:39]
    s_mov_b64 exec, s[44:45]
    s_nop 4
    ds_write_b128 v54, v[24:27] offset:7168
    ds_write_b128 v54, v[28:31] offset:7232
    ds_write_b128 v54, v[32:35] offset:7296
    ds_write_b128 v54, v[36:39] offset:7360
    s_mov_b64 exec, s[40:41]
    s_waitcnt vmcnt(0)
    ds_read_b64_tr_b16 v[192:193], v235 offset:0
    ds_read_b64_tr_b16 v[194:195], v235 offset:1024
    ds_read_b64_tr_b16 v[196:197], v235 offset:32
    ds_read_b64_tr_b16 v[198:199], v235 offset:1056
    ds_read_b64_tr_b16 v[200:201], v235 offset:64
    ds_read_b64_tr_b16 v[202:203], v235 offset:1088
    ds_read_b64_tr_b16 v[204:205], v235 offset:96
    ds_read_b64_tr_b16 v[206:207], v235 offset:1120
    ds_read_b64_tr_b16 v[208:209], v235 offset:128
    ds_read_b64_tr_b16 v[210:211], v235 offset:1152
    ds_read_b64_tr_b16 v[212:213], v235 offset:160
    ds_read_b64_tr_b16 v[214:215], v235 offset:1184
    ds_read_b64_tr_b16 v[216:217], v235 offset:192
    ds_read_b64_tr_b16 v[218:219], v235 offset:1216
    ds_read_b64_tr_b16 v[220:221], v235 offset:224
    ds_read_b64_tr_b16 v[222:223], v235 offset:1248
    v_lshlrev_b32 v44, 16, v58
    v_and_b32 v45, 0xffff0000, v58
    v_lshlrev_b32 v46, 16, v59
    v_and_b32 v47, 0xffff0000, v59
    s_mov_b32 s96, 100000
    buffer_load_dwordx4 v[64:67], v229, s[48:51], s88 offen offset:0 sc1
    buffer_load_dwordx4 v[68:71], v229, s[48:51], s88 offen offset:2048 sc1
    buffer_load_dwordx4 v[72:75], v229, s[48:51], s89 offen offset:0 sc1
    buffer_load_dwordx4 v[76:79], v229, s[48:51], s89 offen offset:2048 sc1
    buffer_load_dwordx4 v[80:83], v229, s[48:51], s90 offen offset:0 sc1
    buffer_load_dwordx4 v[84:87], v229, s[48:51], s90 offen offset:2048 sc1
    buffer_load_dwordx4 v[88:91], v229, s[48:51], s91 offen offset:0 sc1
    buffer_load_dwordx4 v[92:95], v229, s[48:51], s91 offen offset:2048 sc1
    s_waitcnt vmcnt(0)
    v_max3_u32 v252, v64, v65, v66
    v_max_u32 v252, v252, v67
    v_cmp_eq_u32 s[20:21], -1, v252
    v_max3_u32 v253, v68, v69, v70
    v_max_u32 v253, v253, v71
    v_cmp_eq_u32 s[22:23], -1, v253
    v_max3_u32 v252, v72, v73, v74
    v_max_u32 v252, v252, v75
    v_cmp_eq_u32 s[24:25], -1, v252
    v_max3_u32 v253, v76, v77, v78
    v_max_u32 v253, v253, v79
    v_cmp_eq_u32 s[26:27], -1, v253
    v_max3_u32 v252, v80, v81, v82
    v_max_u32 v252, v252, v83
    v_cmp_eq_u32 s[32:33], -1, v252
    v_max3_u32 v253, v84, v85, v86
    v_max_u32 v253, v253, v87
    v_cmp_eq_u32 s[34:35], -1, v253
    v_max3_u32 v252, v88, v89, v90
    v_max_u32 v252, v252, v91
    v_cmp_eq_u32 s[36:37], -1, v252
    v_max3_u32 v253, v92, v93, v94
    v_max_u32 v253, v253, v95
    v_cmp_eq_u32 s[38:39], -1, v253
    s_bcnt1_i32_b64 s92, s[20:21]
    s_bcnt1_i32_b64 s93, s[22:23]
    s_add_u32 s92, s92, s93
    s_bcnt1_i32_b64 s93, s[24:25]
    s_add_u32 s92, s92, s93
    s_bcnt1_i32_b64 s93, s[26:27]
    s_add_u32 s92, s92, s93
    s_bcnt1_i32_b64 s93, s[32:33]
    s_add_u32 s92, s92, s93
    s_bcnt1_i32_b64 s93, s[34:35]
    s_add_u32 s92, s92, s93
    s_bcnt1_i32_b64 s93, s[36:37]
    s_add_u32 s92, s92, s93
    s_bcnt1_i32_b64 s93, s[38:39]
    s_add_u32 s92, s92, s93
    s_cmp_eq_u32 s92, 0
    s_cbranch_scc1 L_h2d_17
L_h2_15:
    s_mov_b64 exec, s[20:21]
    buffer_load_dwordx4 v[64:67], v229, s[48:51], s88 offen offset:0 sc1
    s_mov_b64 exec, s[22:23]
    buffer_load_dwordx4 v[68:71], v229, s[48:51], s88 offen offset:2048 sc1
    s_mov_b64 exec, s[24:25]
    buffer_load_dwordx4 v[72:75], v229, s[48:51], s89 offen offset:0 sc1
    s_mov_b64 exec, s[26:27]
    buffer_load_dwordx4 v[76:79], v229, s[48:51], s89 offen offset:2048 sc1
    s_mov_b64 exec, s[32:33]
    buffer_load_dwordx4 v[80:83], v229, s[48:51], s90 offen offset:0 sc1
    s_mov_b64 exec, s[34:35]
    buffer_load_dwordx4 v[84:87], v229, s[48:51], s90 offen offset:2048 sc1
    s_mov_b64 exec, s[36:37]
    buffer_load_dwordx4 v[88:91], v229, s[48:51], s91 offen offset:0 sc1
    s_mov_b64 exec, s[38:39]
    buffer_load_dwordx4 v[92:95], v229, s[48:51], s91 offen offset:2048 sc1
    s_mov_b64 exec, s[40:41]
    s_cmp_le_u32 s92, 128
    s_cbranch_scc1 L_h2f_16
    s_waitcnt vmcnt(0)
L_h2f_16:
    s_waitcnt vmcnt(40)
    v_max3_u32 v252, v64, v65, v66
    v_max_u32 v252, v252, v67
    v_cmp_eq_u32 s[20:21], -1, v252
    v_max3_u32 v253, v68, v69, v70
    v_max_u32 v253, v253, v71
    v_cmp_eq_u32 s[22:23], -1, v253
    v_max3_u32 v252, v72, v73, v74
    v_max_u32 v252, v252, v75
    v_cmp_eq_u32 s[24:25], -1, v252
    v_max3_u32 v253, v76, v77, v78
    v_max_u32 v253, v253, v79
    v_cmp_eq_u32 s[26:27], -1, v253
    v_max3_u32 v252, v80, v81, v82
    v_max_u32 v252, v252, v83
    v_cmp_eq_u32 s[32:33], -1, v252
    v_max3_u32 v253, v84, v85, v86
    v_max_u32 v253, v253, v87
    v_cmp_eq_u32 s[34:35], -1, v253
    v_max3_u32 v252, v88, v89, v90
    v_max_u32 v252, v252, v91
    v_cmp_eq_u32 s[36:37], -1, v252
    v_max3_u32 v253, v92, v93, v94
    v_max_u32 v253, v253, v95
    v_cmp_eq_u32 s[38:39], -1, v253
    s_bcnt1_i32_b64 s92, s[20:21]
    s_bcnt1_i32_b64 s93, s[22:23]
    s_add_u32 s92, s92, s93
    s_bcnt1_i32_b64 s93, s[24:25]
    s_add_u32 s92, s92, s93
    s_bcnt1_i32_b64 s93, s[26:27]
    s_add_u32 s92, s92, s93
    s_bcnt1_i32_b64 s93, s[32:33]
    s_add_u32 s92, s92, s93
    s_bcnt1_i32_b64 s93, s[34:35]
    s_add_u32 s92, s92, s93
    s_bcnt1_i32_b64 s93, s[36:37]
    s_add_u32 s92, s92, s93
    s_bcnt1_i32_b64 s93, s[38:39]
    s_add_u32 s92, s92, s93
    s_cmp_eq_u32 s92, 0
    s_cbranch_scc1 L_h2d_17
    s_sub_u32 s96, s96, 1
    s_cmp_eq_u32 s96, 0
    s_cbranch_scc1 L_h2d_17
    s_sleep 1
    s_branch L_h2_15
L_h2d_17:
    v_pk_add_f32 v[8:9], v[64:65], v[68:69]
    v_pk_add_f32 v[10:11], v[66:67], v[70:71]
    v_pk_add_f32 v[12:13], v[72:73], v[76:77]
    v_pk_add_f32 v[14:15], v[74:75], v[78:79]
    v_pk_add_f32 v[16:17], v[80:81], v[84:85]
    v_pk_add_f32 v[18:19], v[82:83], v[86:87]
    v_pk_add_f32 v[20:21], v[88:89], v[92:93]
    v_pk_add_f32 v[22:23], v[90:91], v[94:95]
    v_pk_add_f32 v[8:9], v[8:9], v[12:13]
    v_pk_add_f32 v[10:11], v[10:11], v[14:15]
    v_pk_add_f32 v[16:17], v[16:17], v[20:21]
    v_pk_add_f32 v[18:19], v[18:19], v[22:23]
    v_pk_add_f32 v[8:9], v[8:9], v[16:17]
    v_pk_add_f32 v[10:11], v[10:11], v[18:19]
    v_cvt_pk_bf16_f32 v40, 0, v8
    v_cvt_pk_bf16_f32 v41, 0, v9
    v_cvt_pk_bf16_f32 v42, 0, v10
    v_cvt_pk_bf16_f32 v43, 0, v11
    v_pk_add_f32 v[40:41], v[40:41], v[44:45]
    v_pk_add_f32 v[42:43], v[42:43], v[46:47]
    v_cvt_pk_bf16_f32 v50, v40, v41
    v_cvt_pk_bf16_f32 v51, v42, v43
    ds_write_b64 v225, v[50:51]
    ds_read_b128 v[8:11], v224 offset:0
    ds_read_b128 v[12:15], v224 offset:64
    ds_read_b128 v[16:19], v224 offset:128
    ds_read_b128 v[20:23], v224 offset:192
    v_lshlrev_b32 v40, 16, v50
    v_and_b32 v41, 0xffff0000, v50
    v_lshlrev_b32 v42, 16, v51
    v_and_b32 v43, 0xffff0000, v51
    v_pk_add_f32 v[104:105], v[40:41], v[42:43]
    v_add_f32 v104, v104, v105
    s_nop 1
    v_add_f32_dpp v104, v104, v104 row_ror:8 row_mask:0xf bank_mask:0xf
    s_nop 1
    v_add_f32_dpp v104, v104, v104 row_ror:4 row_mask:0xf bank_mask:0xf
    s_nop 1
    v_add_f32_dpp v104, v104, v104 row_ror:2 row_mask:0xf bank_mask:0xf
    s_nop 1
    v_add_f32_dpp v104, v104, v104 row_ror:1 row_mask:0xf bank_mask:0xf
    v_mov_b32 v105, v104
    s_nop 1
    v_permlane16_swap_b32 v104, v105
    s_nop 1
    v_add_f32 v104, v104, v105
    s_waitcnt lgkmcnt(3)
    v_mfma_f32_16x16x32_bf16 v[24:27], v[128:131], v[8:11], 0
    v_mul_f32 v108, 0x3c000000, v104
    v_mul_f32 v106, 0xbc000000, v104
    v_mfma_f32_16x16x32_bf16 v[28:31], v[132:135], v[8:11], 0
    v_mul_f32 v107, 0xbc000000, v104
    v_pk_add_f32 v[110:111], v[40:41], v[106:107]
    v_mfma_f32_16x16x32_bf16 v[32:35], v[136:139], v[8:11], 0
    v_pk_add_f32 v[112:113], v[42:43], v[106:107]
    v_pk_mul_f32 v[110:111], v[110:111], v[110:111]
    v_mfma_f32_16x16x32_bf16 v[36:39], v[140:143], v[8:11], 0
    v_pk_fma_f32 v[110:111], v[112:113], v[112:113], v[110:111]
    v_add_f32 v109, v110, v111
    s_waitcnt lgkmcnt(2)
    v_mfma_f32_16x16x32_bf16 v[24:27], v[144:147], v[12:15], v[24:27]
    s_nop 1
    v_add_f32_dpp v109, v109, v109 row_ror:8 row_mask:0xf bank_mask:0xf
    v_mfma_f32_16x16x32_bf16 v[28:31], v[148:151], v[12:15], v[28:31]
    s_nop 1
    v_add_f32_dpp v109, v109, v109 row_ror:4 row_mask:0xf bank_mask:0xf
    v_mfma_f32_16x16x32_bf16 v[32:35], v[152:155], v[12:15], v[32:35]
    s_nop 1
    v_add_f32_dpp v109, v109, v109 row_ror:2 row_mask:0xf bank_mask:0xf
    v_mfma_f32_16x16x32_bf16 v[36:39], v[156:159], v[12:15], v[36:39]
    s_nop 1
    v_add_f32_dpp v109, v109, v109 row_ror:1 row_mask:0xf bank_mask:0xf
    s_waitcnt lgkmcnt(1)
    v_mfma_f32_16x16x32_bf16 v[24:27], v[160:163], v[16:19], v[24:27]
    v_mov_b32 v105, v109
    s_nop 1
    v_mfma_f32_16x16x32_bf16 v[28:31], v[164:167], v[16:19], v[28:31]
    v_permlane16_swap_b32 v109, v105
    s_nop 1
    v_mfma_f32_16x16x32_bf16 v[32:35], v[168:171], v[16:19], v[32:35]
    v_add_f32 v109, v109, v105
    v_mfma_f32_16x16x32_bf16 v[36:39], v[172:175], v[16:19], v[36:39]
    s_waitcnt lgkmcnt(0)
    v_mfma_f32_16x16x32_bf16 v[24:27], v[176:179], v[20:23], v[24:27]
    v_mfma_f32_16x16x32_bf16 v[28:31], v[180:183], v[20:23], v[28:31]
    v_mfma_f32_16x16x32_bf16 v[32:35], v[184:187], v[20:23], v[32:35]
    v_mfma_f32_16x16x32_bf16 v[36:39], v[188:191], v[20:23], v[36:39]
    ds_write_b128 v230, v[40:43] offset:0
    s_mov_b64 exec, s[28:29]
    ds_write_b64 v231, v[108:109] offset:10240
    s_mov_b64 exec, s[40:41]
    s_mov_b64 exec, s[30:31]
    s_nop 4
    ds_write_b128 v227, v[24:27] offset:8192
    ds_write_b128 v227, v[28:31] offset:8256
    ds_write_b128 v227, v[32:35] offset:8320
    ds_write_b128 v227, v[36:39] offset:8384
    s_mov_b64 exec, s[40:41]
    s_waitcnt lgkmcnt(0)
    s_cmp_lg_u32 s97, 0
    s_cbranch_scc1 L_nb_18
    s_barrier
L_nb_18:
    ds_read_b128 v[32:35], v232 offset:10240
    ds_read_b128 v[36:39], v232 offset:10256
    ds_read_b32 v8, v228 offset:8192
    ds_read_b32 v12, v228 offset:8320
    ds_read_b32 v16, v55 offset:7168
    ds_read_b32 v20, v55 offset:7296
    ds_read_b32 v9, v228 offset:8704
    ds_read_b32 v13, v228 offset:8832
    ds_read_b32 v17, v55 offset:7424
    ds_read_b32 v21, v55 offset:7552
    ds_read_b32 v10, v228 offset:9216
    ds_read_b32 v14, v228 offset:9344
    ds_read_b32 v18, v55 offset:7680
    ds_read_b32 v22, v55 offset:7808
    ds_read_b32 v11, v228 offset:9728
    ds_read_b32 v15, v228 offset:9856
    ds_read_b32 v19, v55 offset:7936
    ds_read_b32 v23, v55 offset:8064
    s_waitcnt lgkmcnt(15)
    v_pk_add_f32 v[24:25], v[32:33], v[34:35]
    v_pk_add_f32 v[26:27], v[36:37], v[38:39]
    v_pk_add_f32 v[24:25], v[24:25], v[26:27]
    v_mul_f32 v27, 0x3e800000, v24
    v_mul_f32 v25, 0x3b000000, v25
    v_sub_f32 v32, v32, v27
    v_sub_f32 v34, v34, v27
    v_sub_f32 v36, v36, v27
    v_sub_f32 v38, v38, v27
    v_mul_f32 v28, v32, v32
    v_mul_f32 v29, v36, v36
    v_fma_f32 v28, v34, v34, v28
    v_fma_f32 v29, v38, v38, v29
    v_cvt_pk_bf16_f32 v27, 0, v27
    v_add_f32 v28, v28, v29
    v_fmac_f32 v25, 0x3e800000, v28
    v_cvt_pk_bf16_f32 v28, 0, v25
    v_add_f32 v28, 0x3727c5ac, v28
    v_cvt_pk_bf16_f32 v28, 0, v28
    v_sqrt_f32 v28, v28
    s_waitcnt lgkmcnt(0)
    v_pk_add_f32 v[8:9], v[8:9], v[10:11]
    v_pk_add_f32 v[16:17], v[16:17], v[18:19]
    v_cvt_pk_bf16_f32 v28, 0, v28
    v_pk_add_f32 v[12:13], v[12:13], v[14:15]
    v_pk_add_f32 v[20:21], v[20:21], v[22:23]
    v_rcp_f32 v28, v28
    v_add_f32 v8, v8, v9
    v_add_f32 v16, v16, v17
    v_add_f32 v12, v12, v13
    v_add_f32 v20, v20, v21
    v_fma_f32 v8, -v27, v16, v8
    v_fma_f32 v12, -v27, v20, v12
    v_mul_f32 v8, v8, v28
    v_mul_f32 v12, v12, v28
    v_cvt_pk_bf16_f32 v8, 0, v8
    v_cvt_pk_bf16_f32 v12, 0, v12
    v_mul_f32 v16, v8, v8
    v_mov_b32 v17, 1.0
    v_fmac_f32 v17, 0x3d372713, v16
    v_mul_f32 v16, v17, v8
    v_mul_f32 v16, 0xc0135761, v16
    v_exp_f32 v16, v16
    s_nop 0
    v_add_f32 v16, 1.0, v16
    v_rcp_f32 v16, v16
    s_nop 0
    v_mul_f32 v16, v16, v8
    v_cvt_pk_bf16_f32 v16, 0, v16
    v_mul_f32 v16, v16, v12
    v_cvt_pk_bf16_f32 v16, v16, v16
    ds_write_b16 v249, v16
    ds_read_b128 v[128:131], v248 offset:0
    ds_read_b128 v[132:135], v248 offset:128
    ds_read_b128 v[136:139], v248 offset:256
    ds_read_b128 v[140:143], v248 offset:384
    ds_read_b128 v[144:147], v248 offset:512
    ds_read_b128 v[148:151], v248 offset:640
    ds_read_b128 v[152:155], v248 offset:768
    ds_read_b128 v[156:159], v248 offset:896
    s_mul_i32 s78, s94, 56
    s_add_u32 s79, s78, s77
    s_lshl_b32 s79, s79, 11
    s_lshl_b32 s80, s70, 9
    s_add_u32 s79, s79, s80
    s_add_u32 s79, s79, 1114112
    s_waitcnt lgkmcnt(7)
    v_mfma_f32_16x16x32_bf16 v[12:15], v[192:195], v[128:131], 0
    s_waitcnt lgkmcnt(6)
    v_mfma_f32_16x16x32_bf16 v[16:19], v[196:199], v[132:135], 0
    s_waitcnt lgkmcnt(5)
    v_mfma_f32_16x16x32_bf16 v[12:15], v[200:203], v[136:139], v[12:15]
    s_waitcnt lgkmcnt(4)
    v_mfma_f32_16x16x32_bf16 v[16:19], v[204:207], v[140:143], v[16:19]
    s_waitcnt lgkmcnt(3)
    v_mfma_f32_16x16x32_bf16 v[12:15], v[208:211], v[144:147], v[12:15]
    s_waitcnt lgkmcnt(2)
    v_mfma_f32_16x16x32_bf16 v[16:19], v[212:215], v[148:151], v[16:19]
    s_waitcnt lgkmcnt(1)
    v_mfma_f32_16x16x32_bf16 v[12:15], v[216:219], v[152:155], v[12:15]
    s_waitcnt lgkmcnt(0)
    v_mfma_f32_16x16x32_bf16 v[16:19], v[220:223], v[156:159], v[16:19]
    s_nop 7
    v_pk_add_f32 v[12:13], v[12:13], v[16:17]
    v_pk_add_f32 v[14:15], v[14:15], v[18:19]
    buffer_store_dwordx4 v[12:15], v250, s[48:51], s79 offen sc1
    s_mov_b64 exec, s[40:41]
    s_cmp_ge_u32 s77, 32
    s_cbranch_scc1 L_tailend
    s_lshl_b32 s80, s77, 2
    s_add_u32 s80, s80, s70
    s_lshl_b32 s79, s78, 11
    s_lshl_b32 s81, s80, 4
    s_add_u32 s79, s79, s81
    s_add_u32 s88, s79, 1114112
    s_add_u32 s89, s88, 114688
    v_add_u32 v5, s81, v251
    ds_read_b32 v44, v5 offset:0
    s_lshl_b32 s78, s94, 10
    s_lshl_b32 s79, s80, 3
    s_add_u32 s78, s78, s79
    v_cmp_gt_u32 vcc, 56, v0
    s_mov_b32 s96, 100000
    buffer_load_dwordx4 v[96:99], v52, s[48:51], s88 offen sc1
    buffer_load_dwordx4 v[100:103], v52, s[48:51], s89 offen sc1
    s_waitcnt vmcnt(0)
    v_max3_u32 v252, v96, v97, v98
    v_max_u32 v252, v252, v99
    v_cmp_eq_u32 s[20:21], -1, v252
    v_max3_u32 v253, v100, v101, v102
    v_max_u32 v253, v253, v103
    v_cmp_eq_u32 s[22:23], -1, v253
    s_bcnt1_i32_b64 s92, s[20:21]
    s_bcnt1_i32_b64 s93, s[22:23]
    s_add_u32 s92, s92, s93
    s_cmp_eq_u32 s92, 0
    s_cbranch_scc1 L_h3d_21
L_h3_19:
    s_mov_b64 exec, s[20:21]
    buffer_load_dwordx4 v[96:99], v52, s[48:51], s88 offen sc1
    s_mov_b64 exec, s[22:23]
    buffer_load_dwordx4 v[100:103], v52, s[48:51], s89 offen sc1
    s_mov_b64 exec, s[40:41]
    s_cmp_le_u32 s92, 16
    s_cbranch_scc1 L_h3f_20
    s_waitcnt vmcnt(0)
L_h3f_20:
    s_waitcnt vmcnt(10)
    v_max3_u32 v252, v96, v97, v98
    v_max_u32 v252, v252, v99
    v_cmp_eq_u32 s[20:21], -1, v252
    v_max3_u32 v253, v100, v101, v102
    v_max_u32 v253, v253, v103
    v_cmp_eq_u32 s[22:23], -1, v253
    s_bcnt1_i32_b64 s92, s[20:21]
    s_bcnt1_i32_b64 s93, s[22:23]
    s_add_u32 s92, s92, s93
    s_cmp_eq_u32 s92, 0
    s_cbranch_scc1 L_h3d_21
    s_sub_u32 s96, s96, 1
    s_cmp_eq_u32 s96, 0
    s_cbranch_scc1 L_h3d_21
    s_sleep 1
    s_branch L_h3_19
L_h3d_21:
    v_cndmask_b32 v8, 0, v96, vcc
    v_cndmask_b32 v9, 0, v97, vcc
    v_cndmask_b32 v10, 0, v98, vcc
    v_cndmask_b32 v11, 0, v99, vcc
    v_cndmask_b32 v12, 0, v100, vcc
    v_cndmask_b32 v13, 0, v101, vcc
    v_cndmask_b32 v14, 0, v102, vcc
    v_cndmask_b32 v15, 0, v103, vcc
    v_permlane32_swap_b32 v8, v9
    v_permlane32_swap_b32 v10, v11
    v_permlane32_swap_b32 v12, v13
    v_permlane32_swap_b32 v14, v15
    s_nop 0
    v_add_f32 v8, v8, v9
    v_add_f32 v10, v10, v11
    v_add_f32 v12, v12, v13
    v_add_f32 v14, v14, v15
    s_nop 0
    v_permlane16_swap_b32 v8, v10
    v_permlane16_swap_b32 v12, v14
    s_nop 1
    v_add_f32 v8, v8, v10
    v_add_f32 v12, v12, v14
    s_nop 1
    v_add_f32_dpp v9, v8, v8 row_ror:8 row_mask:0xf bank_mask:0x3
    v_add_f32_dpp v9, v12, v12 row_ror:8 row_mask:0xf bank_mask:0xc
    s_nop 1
    v_add_f32_dpp v9, v9, v9 row_half_mirror row_mask:0xf bank_mask:0xf
    s_nop 1
    v_add_f32_dpp v9, v9, v9 quad_perm:[2,3,0,1] row_mask:0xf bank_mask:0xf
    s_nop 1
    v_add_f32_dpp v9, v9, v9 quad_perm:[1,0,3,2] row_mask:0xf bank_mask:0xf
    v_cvt_pk_bf16_f32 v9, 0, v9
    s_waitcnt lgkmcnt(0)
    v_add_f32 v9, v9, v44
    v_cvt_pk_bf16_f32 v9, v9, v9
    s_mov_b64 exec, s[46:47]
    buffer_store_short v9, v226, s[64:67], s78 offen
L_tailend:
    s_cmp_eq_u32 s97, 0
    s_cbranch_scc0 L_afterdry
    s_waitcnt vmcnt(0)
L_end:
    s_endpgm
.section .rodata,"a"
.p2align 6
.amdhsa_kernel sequential_preLN__gqa_block_cached__geglu_ffn__decode_kernel
  .amdhsa_next_free_vgpr 256
  .amdhsa_next_free_sgpr 102
  .amdhsa_accum_offset 256
  .amdhsa_group_segment_fixed_size 0
  .amdhsa_kernarg_size 96
  .amdhsa_user_sgpr_count 2
  .amdhsa_user_sgpr_kernarg_segment_ptr 1
  .amdhsa_system_sgpr_workgroup_id_x 1
  .amdhsa_float_denorm_mode_32 3
.end_amdhsa_kernel
.text
```
